```python
import torch

def _softmax(x, axis=-1):
    return torch.softmax(x, dim=axis)
def _gelu(x):
    return torch.nn.functional.gelu(x, approximate="tanh")
def _silu(x):
    return torch.nn.functional.silu(x)
def _sigmoid(x):
    return torch.sigmoid(x)
def _layernorm(x, axis=-1, eps=1e-5):
    m = x.mean(dim=axis, keepdim=True)
    v = x.var(dim=axis, keepdim=True, unbiased=False)
    return (x - m) / torch.sqrt(v + eps)
def _scatter_add(tgt, idx, src, axis=0):
    return tgt.clone().index_add_(axis, idx, src)
def _segment_sum(src, seg, n):
    out = torch.zeros((n,) + src.shape[1:], dtype=src.dtype)
    return out.index_add_(0, seg, src)
def _pad(x, pw):
    flat = tuple(v for pair in reversed(pw) for v in pair)
    return torch.nn.functional.pad(x, flat)

kernel_name = 'recurrent_scan__compressed_kv_cla__moe_arch_mod__decode'

def setup_inputs():

    _w = (lambda a: (lambda t: t.to(torch.bfloat16) if t.is_floating_point() else t)(torch.as_tensor(a)))
    def _A_setup():
        B, H, Sq, Sk, D, M = 4, 32, 1, 4096, 128, 512
        Dc = 4 * D
        return {
            "x": _w((lambda *s: torch.randn(*s, dtype=torch.bfloat16) * 0.05)(B, Sq, M)),
            "c_kv": _w((lambda *s: torch.randn(*s, dtype=torch.bfloat16) * 0.8)(B, Sk, Dc)),
            "w_q": _w((lambda *s: torch.randn(*s, dtype=torch.bfloat16) * 1.6)(M, H, D) * (M ** -0.5)),
            "w_uk": _w((lambda *s: torch.randn(*s, dtype=torch.bfloat16) * 1.6)(Dc, H, D) * (Dc ** -0.5)),
            "w_uv": _w((lambda *s: torch.randn(*s, dtype=torch.bfloat16) * 0.8)(Dc, H, D) * (Dc ** -0.5)),
            "w_o": _w((lambda *s: torch.randn(*s, dtype=torch.bfloat16) * 0.8)(H, D, M) * ((H * D) ** -0.5)),
        }
    _A_in = _A_setup()

    def _B_setup():
        B, S, D, F, C = 4, 1, 512, 1792, 1
        return {
            "x": _w((lambda *s: torch.randn(*s, dtype=torch.bfloat16) * 0.05)(B, S, D)),
            "w_r": _w((lambda *s: torch.randn(*s, dtype=torch.bfloat16) * 0.8)(D)),
            "w_gate": _w((lambda *s: torch.randn(*s, dtype=torch.bfloat16) * 0.2)(D, F)),
            "w_up": _w((lambda *s: torch.randn(*s, dtype=torch.bfloat16) * 0.2)(D, F)),
            "w_down": _w((lambda *s: torch.randn(*s, dtype=torch.bfloat16) * 0.2)(F, D)),
        }
    _B_in = _B_setup()

    return {
        "A_x": _A_in["x"],
        "A_c_kv": _A_in["c_kv"],
        "A_w_q": _A_in["w_q"],
        "A_w_uk": _A_in["w_uk"],
        "A_w_uv": _A_in["w_uv"],
        "A_w_o": _A_in["w_o"],
        "B_x": _B_in["x"],
        "B_w_r": _B_in["w_r"],
        "B_w_gate": _B_in["w_gate"],
        "B_w_up": _B_in["w_up"],
        "B_w_down": _B_in["w_down"],
    }

def reference(A_x, A_c_kv, A_w_q, A_w_uk, A_w_uv, A_w_o, B_x, B_w_r, B_w_gate, B_w_up, B_w_down):
    def _A_ref(x, c_kv, w_q, w_uk, w_uv, w_o):
        B, Sq, M = x.shape[0], x.shape[1], x.shape[2]
        Sk = c_kv.shape[1]
        H, D = w_q.shape[1], w_q.shape[2]
        q = torch.einsum("bqm,mhd->bhqd", x, w_q)
        k = torch.einsum("bkc,chd->bhkd", c_kv, w_uk)
        v = torch.einsum("bkc,chd->bhkd", c_kv, w_uv)
        scores = torch.einsum("bhqd,bhkd->bhqk", q, k) * (D ** -0.5)
        off = Sk - Sq
        qi = torch.arange(Sq)[:, None]
        kj = torch.arange(Sk)[None, :]
        cmask = kj <= (qi + off)
        scores = torch.where(cmask[None, None], scores, -1e9)
        p = _softmax(scores, axis=-1)
        ctx = torch.einsum("bhqk,bhkd->bhqd", p, v)
        return torch.einsum("bhqd,hdm->bqm", ctx, w_o)

    def _B_ref(x, w_r, w_gate, w_up, w_down):
        B, S, D = x.shape
        C = 1
        r = x @ w_r
        idx = torch.argsort(-r, axis=-1)[:, :C]
        idx_e = (lambda x, n, axis: torch.repeat_interleave(x, n, dim=axis))(idx.reshape(B, C, 1), D, axis=2)
        x_sel = (lambda x, i, axis: torch.take_along_dim(x, i, dim=axis))(x, idx_e, axis=1)
        g = _silu(x_sel @ w_gate)
        u = x_sel @ w_up
        y = (g * u) @ w_down
        r_sel = _sigmoid((lambda x, i, axis: torch.take_along_dim(x, i, dim=axis))(r, idx, axis=1))
        y = y * r_sel.reshape(B, C, 1)
        b_off = (torch.arange(B) * S).reshape(B, 1)
        flat_idx = (idx + b_off).reshape(B * C)
        zero = (x * 0.0).reshape(B * S, D)
        upd = _scatter_add(zero, flat_idx, y.reshape(B * C, D), axis=0)
        return x + upd.reshape(B, S, D)

    x = A_x
    xn = _layernorm(x, axis=-1)
    s = _A_ref(xn, A_c_kv, A_w_q, A_w_uk, A_w_uv, A_w_o)
    g = _silu(_B_ref(xn, B_w_r, B_w_gate, B_w_up, B_w_down))
    return x + s * g
```

```asm
; @launch kernel=k1_kernel grid=(256,1,1) block=(1024,1,1) lds=156480
; @launch kernel=k2_kernel grid=(256,1,1) block=(1024,1,1) lds=152576
; @launch kernel=k3_kernel grid=(256,1,1) block=(1024,1,1) lds=50432
; @launch kernel=k4_kernel grid=(64,1,1) block=(512,1,1) lds=2048
.amdgcn_target "amdgcn-amd-amdhsa--gfx950"
.text
.globl k1_kernel
.p2align 8
.type k1_kernel,@function
k1_kernel:
    s_cmp_ge_u32 s2, 256
    s_cbranch_scc1 K1_END
    s_load_dwordx2 s[4:5], s[0:1], 0
    s_load_dwordx4 s[8:11], s[0:1], 16
    s_load_dwordx2 s[12:13], s[0:1], 56
    s_load_dwordx4 s[16:19], s[0:1], 64
    s_load_dwordx2 s[20:21], s[0:1], 104
    s_load_dwordx2 s[22:23], s[0:1], 32
    s_load_dwordx2 s[6:7], s[0:1], 8
    v_and_b32 v1, 63, v0
    v_lshrrev_b32 v4, 6, v0
    v_lshrrev_b32 v2, 4, v1
    v_and_b32 v3, 15, v1
    v_readfirstlane_b32 s52, v4
    v_lshlrev_b32 v11, 4, v1
    s_and_b32 s57, s2, 7
    s_lshr_b32 s58, s2, 3
    s_and_b32 s59, s58, 3
    s_lshl_b32 s53, s57, 2
    s_add_u32 s53, s53, s59
    s_lshr_b32 s54, s2, 5
    s_mov_b32 s56, 1
    s_mov_b32 s59, s2
    s_cmp_lt_u32 s2, 224
    s_cbranch_scc1 K1_LGOK
    s_mov_b32 s56, 0
    s_sub_u32 s59, s2, 224
K1_LGOK:
    s_mul_i32 s60, s59, 2341
    s_lshr_b32 s55, s60, 16
    s_mul_i32 s60, s55, 28
    s_sub_u32 s66, s59, s60
    v_lshrrev_b32 v5, 1, v3
    v_sub_u32 v6, v5, v2
    v_and_b32 v7, 7, v6
    v_subrev_u32 v6, 4, v6
    v_and_b32 v8, 7, v6
    v_and_b32 v9, 1, v3
    v_lshlrev_b32 v10, 13, v2
    v_lshl_or_b32 v7, v7, 1, v9
    v_lshl_or_b32 v8, v8, 1, v9
    v_lshl_add_u32 v7, v7, 4, v10
    v_lshl_add_u32 v8, v8, 4, v10
    v_lshrrev_b32 v12, 3, v1
    v_mul_u32_u24 v12, 3584, v12
    v_and_b32 v15, 7, v1
    v_lshl_add_u32 v12, v15, 4, v12
    v_lshl_add_u32 v13, v3, 4, v10
    s_lshl_b32 s68, s54, 1
    s_add_u32 s68, s68, s52
    s_and_b32 s68, s68, 15
    s_lshl_b32 s62, s53, 8
    s_lshl_b32 s61, s68, 18
    s_add_u32 s61, s61, s62
    s_lshl_b32 s63, s68, 13
    s_waitcnt lgkmcnt(0)
    s_mov_b32 s24, s4
    s_and_b32 s25, s5, 0xffff
    s_mov_b32 s26, 0x1000
    s_mov_b32 s27, 0x00020000
    s_mov_b32 s28, s8
    s_and_b32 s29, s9, 0xffff
    s_mov_b32 s30, 0x400000
    s_mov_b32 s31, 0x00020000
    s_mov_b32 s36, s12
    s_and_b32 s37, s13, 0xffff
    s_mov_b32 s38, 0x400
    s_mov_b32 s39, 0x00020000
    s_cmp_ge_u32 s52, 4
    s_cbranch_scc1 K1_NOX
    s_lshl_b32 s60, s52, 10
    buffer_load_dwordx4 v[16:19], v11, s[24:27], s60 offen
    buffer_load_dwordx4 v[20:23], v11, s[36:39], 0 offen
K1_NOX:
    s_add_u32 m0, s63, 0
    s_add_u32 s64, s61, 0
    buffer_load_dwordx4 v7, s[28:31], s64 offen lds
    s_add_u32 m0, s63, 1024
    s_add_u32 s64, s61, 32768
    buffer_load_dwordx4 v7, s[28:31], s64 offen lds
    s_add_u32 m0, s63, 2048
    s_add_u32 s64, s61, 65536
    buffer_load_dwordx4 v8, s[28:31], s64 offen lds
    s_add_u32 m0, s63, 3072
    s_add_u32 s64, s61, 98304
    buffer_load_dwordx4 v8, s[28:31], s64 offen lds
    s_add_u32 m0, s63, 4096
    s_add_u32 s64, s61, 131072
    buffer_load_dwordx4 v7, s[28:31], s64 offen lds
    s_add_u32 m0, s63, 5120
    s_add_u32 s64, s61, 163840
    buffer_load_dwordx4 v7, s[28:31], s64 offen lds
    s_add_u32 m0, s63, 6144
    s_add_u32 s64, s61, 196608
    buffer_load_dwordx4 v8, s[28:31], s64 offen lds
    s_add_u32 m0, s63, 7168
    s_add_u32 s64, s61, 229376
    buffer_load_dwordx4 v8, s[28:31], s64 offen lds
    s_mov_b32 s32, s10
    s_and_b32 s33, s11, 0xffff
    s_mov_b32 s34, 0x400000
    s_mov_b32 s35, 0x00020000
    s_mov_b32 s40, s16
    s_and_b32 s41, s17, 0xffff
    s_mov_b32 s42, 0x1c0000
    s_mov_b32 s43, 0x00020000
    s_mov_b32 s44, s18
    s_and_b32 s45, s19, 0xffff
    s_mov_b32 s46, 0x1c0000
    s_mov_b32 s47, 0x00020000
    s_mov_b32 s48, s20
    s_and_b32 s49, s21, 0xffff
    s_mov_b32 s50, 0xd18000
    s_mov_b32 s51, 0x00020000
    s_cmp_lt_u32 s52, 12
    s_cbranch_scc1 K1_NOLATE
    s_sub_u32 s70, s52, 12
    s_lshl_b32 s61, s54, 6
    s_lshl_b32 s64, s70, 4
    s_add_u32 s61, s61, s64
    s_lshl_b32 s65, s61, 5
    s_lshl_b32 s61, s61, 13
    s_add_u32 s71, s61, s62
    s_add_u32 s64, s71, 0
    buffer_load_dwordx4 v[24:27], v13, s[32:35], s64 offen
    s_add_u32 s64, s71, 32768
    buffer_load_dwordx4 v[28:31], v13, s[32:35], s64 offen
    s_add_u32 s64, s71, 65536
    buffer_load_dwordx4 v[32:35], v13, s[32:35], s64 offen
    s_add_u32 s64, s71, 98304
    buffer_load_dwordx4 v[36:39], v13, s[32:35], s64 offen
K1_NOLATE:
    s_cmp_ge_u32 s52, 4
    s_cbranch_scc1 K1_LNDONE
    s_waitcnt vmcnt(8)
    v_lshlrev_b32 v40, 16, v16
    v_and_b32 v41, 0xffff0000, v16
    v_lshlrev_b32 v42, 16, v17
    v_and_b32 v43, 0xffff0000, v17
    v_lshlrev_b32 v44, 16, v18
    v_and_b32 v45, 0xffff0000, v18
    v_lshlrev_b32 v46, 16, v19
    v_and_b32 v47, 0xffff0000, v19
    v_add_f32 v48, v40, v41
    v_add_f32 v49, v42, v43
    v_add_f32 v50, v44, v45
    v_add_f32 v51, v46, v47
    v_add_f32 v48, v48, v49
    v_add_f32 v50, v50, v51
    v_add_f32 v48, v48, v50
    s_nop 1
    v_add_f32_dpp v48, v48, v48 row_shr:1 row_mask:0xf bank_mask:0xf bound_ctrl:0
    s_nop 1
    v_add_f32_dpp v48, v48, v48 row_shr:2 row_mask:0xf bank_mask:0xf bound_ctrl:0
    s_nop 1
    v_add_f32_dpp v48, v48, v48 row_shr:4 row_mask:0xf bank_mask:0xf bound_ctrl:0
    s_nop 1
    v_add_f32_dpp v48, v48, v48 row_shr:8 row_mask:0xf bank_mask:0xf bound_ctrl:0
    s_nop 1
    v_add_f32_dpp v48, v48, v48 row_bcast:15 row_mask:0xa bank_mask:0xf
    s_nop 1
    v_add_f32_dpp v48, v48, v48 row_bcast:31 row_mask:0xc bank_mask:0xf
    s_nop 1
    v_readlane_b32 s70, v48, 63
    v_mov_b32 v49, 0x3b000000
    s_nop 1
    v_mul_f32 v49, s70, v49
    v_mov_b32 v50, 0
    v_sub_f32 v51, v40, v49
    v_fmac_f32 v50, v51, v51
    v_sub_f32 v51, v41, v49
    v_fmac_f32 v50, v51, v51
    v_sub_f32 v51, v42, v49
    v_fmac_f32 v50, v51, v51
    v_sub_f32 v51, v43, v49
    v_fmac_f32 v50, v51, v51
    v_sub_f32 v51, v44, v49
    v_fmac_f32 v50, v51, v51
    v_sub_f32 v51, v45, v49
    v_fmac_f32 v50, v51, v51
    v_sub_f32 v51, v46, v49
    v_fmac_f32 v50, v51, v51
    v_sub_f32 v51, v47, v49
    v_fmac_f32 v50, v51, v51
    s_nop 1
    v_add_f32_dpp v50, v50, v50 row_shr:1 row_mask:0xf bank_mask:0xf bound_ctrl:0
    s_nop 1
    v_add_f32_dpp v50, v50, v50 row_shr:2 row_mask:0xf bank_mask:0xf bound_ctrl:0
    s_nop 1
    v_add_f32_dpp v50, v50, v50 row_shr:4 row_mask:0xf bank_mask:0xf bound_ctrl:0
    s_nop 1
    v_add_f32_dpp v50, v50, v50 row_shr:8 row_mask:0xf bank_mask:0xf bound_ctrl:0
    s_nop 1
    v_add_f32_dpp v50, v50, v50 row_bcast:15 row_mask:0xa bank_mask:0xf
    s_nop 1
    v_add_f32_dpp v50, v50, v50 row_bcast:31 row_mask:0xc bank_mask:0xf
    s_nop 1
    v_readlane_b32 s71, v50, 63
    v_mov_b32 v50, 0x3b000000
    s_nop 1
    v_mul_f32 v50, s71, v50
    v_cvt_pk_bf16_f32 v49, v49, v49
    v_and_b32 v49, 0xffff0000, v49
    v_cvt_pk_bf16_f32 v50, v50, v50
    v_and_b32 v50, 0xffff0000, v50
    v_add_f32 v50, 0x3727c5ac, v50
    v_cvt_pk_bf16_f32 v50, v50, v50
    v_and_b32 v50, 0xffff0000, v50
    v_sqrt_f32 v50, v50
    s_nop 0
    v_cvt_pk_bf16_f32 v50, v50, v50
    v_and_b32 v50, 0xffff0000, v50
    v_rcp_f32 v51, v50
    s_nop 0
    v_sub_f32 v40, v40, v49
    v_cvt_pk_bf16_f32 v40, v40, v40
    v_and_b32 v40, 0xffff0000, v40
    v_mul_f32 v52, v40, v51
    v_fma_f32 v53, -v52, v50, v40
    v_fma_f32 v40, v53, v51, v52
    v_sub_f32 v41, v41, v49
    v_cvt_pk_bf16_f32 v41, v41, v41
    v_and_b32 v41, 0xffff0000, v41
    v_mul_f32 v52, v41, v51
    v_fma_f32 v53, -v52, v50, v41
    v_fma_f32 v41, v53, v51, v52
    v_sub_f32 v42, v42, v49
    v_cvt_pk_bf16_f32 v42, v42, v42
    v_and_b32 v42, 0xffff0000, v42
    v_mul_f32 v52, v42, v51
    v_fma_f32 v53, -v52, v50, v42
    v_fma_f32 v42, v53, v51, v52
    v_sub_f32 v43, v43, v49
    v_cvt_pk_bf16_f32 v43, v43, v43
    v_and_b32 v43, 0xffff0000, v43
    v_mul_f32 v52, v43, v51
    v_fma_f32 v53, -v52, v50, v43
    v_fma_f32 v43, v53, v51, v52
    v_sub_f32 v44, v44, v49
    v_cvt_pk_bf16_f32 v44, v44, v44
    v_and_b32 v44, 0xffff0000, v44
    v_mul_f32 v52, v44, v51
    v_fma_f32 v53, -v52, v50, v44
    v_fma_f32 v44, v53, v51, v52
    v_sub_f32 v45, v45, v49
    v_cvt_pk_bf16_f32 v45, v45, v45
    v_and_b32 v45, 0xffff0000, v45
    v_mul_f32 v52, v45, v51
    v_fma_f32 v53, -v52, v50, v45
    v_fma_f32 v45, v53, v51, v52
    v_sub_f32 v46, v46, v49
    v_cvt_pk_bf16_f32 v46, v46, v46
    v_and_b32 v46, 0xffff0000, v46
    v_mul_f32 v52, v46, v51
    v_fma_f32 v53, -v52, v50, v46
    v_fma_f32 v46, v53, v51, v52
    v_sub_f32 v47, v47, v49
    v_cvt_pk_bf16_f32 v47, v47, v47
    v_and_b32 v47, 0xffff0000, v47
    v_mul_f32 v52, v47, v51
    v_fma_f32 v53, -v52, v50, v47
    v_fma_f32 v47, v53, v51, v52
    v_cvt_pk_bf16_f32 v52, v40, v41
    v_cvt_pk_bf16_f32 v53, v42, v43
    v_cvt_pk_bf16_f32 v54, v44, v45
    v_cvt_pk_bf16_f32 v55, v46, v47
    s_mul_i32 s60, s52, 1088
    s_add_u32 s60, s60, 147456
    v_add_u32 v56, s60, v11
    ds_write_b128 v56, v[52:55]
    v_mov_b32 v56, 156416
    v_mov_b32 v57, 0
    ds_write_b32 v56, v57
    s_cmp_lg_u32 s2, 0
    s_cbranch_scc1 K1_LNDONE
    s_lshl_b32 s60, s52, 10
    s_add_u32 s60, s60, 147456
    buffer_store_dwordx4 v[52:55], v11, s[48:51], s60 offen sc1
    v_mov_b32 v57, 0
    v_lshlrev_b32 v58, 16, v52
    v_lshlrev_b32 v59, 16, v20
    v_fmac_f32 v57, v58, v59
    v_and_b32 v58, 0xffff0000, v52
    v_and_b32 v59, 0xffff0000, v20
    v_fmac_f32 v57, v58, v59
    v_lshlrev_b32 v58, 16, v53
    v_lshlrev_b32 v59, 16, v21
    v_fmac_f32 v57, v58, v59
    v_and_b32 v58, 0xffff0000, v53
    v_and_b32 v59, 0xffff0000, v21
    v_fmac_f32 v57, v58, v59
    v_lshlrev_b32 v58, 16, v54
    v_lshlrev_b32 v59, 16, v22
    v_fmac_f32 v57, v58, v59
    v_and_b32 v58, 0xffff0000, v54
    v_and_b32 v59, 0xffff0000, v22
    v_fmac_f32 v57, v58, v59
    v_lshlrev_b32 v58, 16, v55
    v_lshlrev_b32 v59, 16, v23
    v_fmac_f32 v57, v58, v59
    v_and_b32 v58, 0xffff0000, v55
    v_and_b32 v59, 0xffff0000, v23
    v_fmac_f32 v57, v58, v59
    s_nop 1
    v_add_f32_dpp v57, v57, v57 row_shr:1 row_mask:0xf bank_mask:0xf bound_ctrl:0
    s_nop 1
    v_add_f32_dpp v57, v57, v57 row_shr:2 row_mask:0xf bank_mask:0xf bound_ctrl:0
    s_nop 1
    v_add_f32_dpp v57, v57, v57 row_shr:4 row_mask:0xf bank_mask:0xf bound_ctrl:0
    s_nop 1
    v_add_f32_dpp v57, v57, v57 row_shr:8 row_mask:0xf bank_mask:0xf bound_ctrl:0
    s_nop 1
    v_add_f32_dpp v57, v57, v57 row_bcast:15 row_mask:0xa bank_mask:0xf
    s_nop 1
    v_add_f32_dpp v57, v57, v57 row_bcast:31 row_mask:0xc bank_mask:0xf
    v_cvt_pk_bf16_f32 v57, v57, v57
    v_and_b32 v57, 0xffff0000, v57
    v_mul_f32 v58, 0xbfb8aa3b, v57
    v_exp_f32 v58, v58
    s_nop 0
    v_add_f32 v58, 1.0, v58
    v_rcp_f32 v58, v58
    s_nop 0
    v_cvt_pk_bf16_f32 v58, v58, v58
    v_and_b32 v58, 0xffff0000, v58
    s_lshl_b32 s60, s52, 2
    s_add_u32 s60, s60, 151552
    v_mov_b32 v59, 0
    v_cmp_eq_u32 vcc, 63, v1
    s_and_saveexec_b64 s[74:75], vcc
    buffer_store_dword v58, v59, s[48:51], s60 offen sc1
    s_mov_b64 exec, -1
K1_LNDONE:
    v_and_b32 v4, 3, v3
    v_mul_u32_u24 v4, 1088, v4
    v_lshl_add_u32 v4, v2, 4, v4
    s_lshr_b32 s69, s52, 3
    s_lshl_b32 s60, s69, 9
    s_add_u32 s60, s60, 147456
    v_add_u32 v57, s60, v4
    v_bfe_u32 v5, v1, 2, 2
    v_and_b32 v6, 3, v1
    v_and_b32 v9, 1, v2
    v_lshl_add_u32 v9, v9, 2, v5
    v_lshl_add_u32 v10, v2, 3, v5
    v_lshlrev_b32 v14, 8, v10
    v_lshl_add_u32 v14, v6, 3, v14
    s_and_b32 s60, s52, 7
    v_add_u32 v12, s60, v9
    v_and_b32 v12, 7, v12
    v_lshl_add_u32 v64, v12, 5, v14
    s_lshl_b32 s60, s69, 16
    v_add_u32 v64, s60, v64
    v_lshlrev_b32 v12, 7, v10
    v_lshl_add_u32 v72, v6, 3, v12
    s_and_b32 s60, s52, 7
    s_lshr_b32 s61, s60, 2
    s_lshl_b32 s61, s61, 13
    s_and_b32 s60, s60, 3
    s_lshl_b32 s60, s60, 5
    s_add_u32 s60, s60, s61
    s_add_u32 s60, s60, 131072
    v_add_u32 v72, s60, v72
    s_lshl_b32 s61, s55, 7
    s_add_u32 s61, s61, 147456
    v_add_u32 v73, s61, v4
    s_mul_i32 s60, s55, 4*3584*4
    s_and_b32 s61, s52, 7
    s_lshr_b32 s64, s61, 2
    s_mul_i32 s64, s64, 1792*4
    s_add_u32 s60, s60, s64
    s_and_b32 s61, s61, 3
    s_lshl_b32 s61, s61, 6
    s_add_u32 s60, s60, s61
    s_lshl_b32 s61, s66, 8
    s_add_u32 s60, s60, s61
    s_add_u32 s67, s60, 8585216
    v_mul_u32_u24 v74, 3584*4, v3
    v_lshl_add_u32 v74, v2, 4, v74
    v_lshlrev_b32 v75, 9, v3
    v_lshl_add_u32 v75, v2, 4, v75
    v_and_b32 v5, 1, v3
    v_lshl_add_u32 v75, v5, 4, v75
    v_bfe_u32 v5, v3, 1, 1
    v_lshl_add_u32 v75, v5, 7, v75
    s_mul_i32 s60, s69, 2304
    s_and_b32 s61, s52, 7
    s_lshl_b32 s61, s61, 6
    s_add_u32 s60, s60, s61
    s_add_u32 s60, s60, 151808
    v_add_u32 v75, s60, v75
    v_cmp_gt_u32 vcc, 4, v3
    s_mov_b64 s[72:73], vcc
    s_waitcnt lgkmcnt(0)
    s_barrier
    s_cmp_ge_u32 s52, 4
    s_cbranch_scc1 K1_NOGU2
    v_lshrrev_b32 v12, 3, v1
    v_mul_u32_u24 v12, 3584, v12
    v_and_b32 v15, 7, v1
    v_lshl_add_u32 v12, v15, 4, v12
    s_lshl_b32 s61, s55, 1
    s_and_b32 s64, s52, 1
    s_add_u32 s61, s61, s64
    s_mul_i32 s61, s61, 32*3584
    s_lshl_b32 s64, s66, 7
    s_add_u32 s61, s61, s64
    s_lshl_b32 s64, s52, 12
    s_cmp_ge_u32 s52, 2
    s_cbranch_scc1 K1_UPDMA
    s_add_u32 m0, s64, 131072
    s_add_u32 s65, s61, 0
    buffer_load_dwordx4 v12, s[40:43], s65 offen lds
    s_add_u32 m0, s64, 132096
    s_add_u32 s65, s61, 28672
    buffer_load_dwordx4 v12, s[40:43], s65 offen lds
    s_add_u32 m0, s64, 133120
    s_add_u32 s65, s61, 57344
    buffer_load_dwordx4 v12, s[40:43], s65 offen lds
    s_add_u32 m0, s64, 134144
    s_add_u32 s65, s61, 86016
    buffer_load_dwordx4 v12, s[40:43], s65 offen lds
    s_branch K1_NOGU2
K1_UPDMA:
    s_add_u32 m0, s64, 131072
    s_add_u32 s65, s61, 0
    buffer_load_dwordx4 v12, s[44:47], s65 offen lds
    s_add_u32 m0, s64, 132096
    s_add_u32 s65, s61, 28672
    buffer_load_dwordx4 v12, s[44:47], s65 offen lds
    s_add_u32 m0, s64, 133120
    s_add_u32 s65, s61, 57344
    buffer_load_dwordx4 v12, s[44:47], s65 offen lds
    s_add_u32 m0, s64, 134144
    s_add_u32 s65, s61, 86016
    buffer_load_dwordx4 v12, s[44:47], s65 offen lds
K1_NOGU2:
    ds_read_b128 v[40:43], v57 offset:0
    ds_read_b128 v[44:47], v57 offset:64
    ds_read_b128 v[48:51], v57 offset:128
    ds_read_b128 v[52:55], v57 offset:192
    ds_read_b128 v[80:83], v57 offset:256
    ds_read_b128 v[84:87], v57 offset:320
    ds_read_b128 v[88:91], v57 offset:384
    ds_read_b128 v[92:95], v57 offset:448
    s_cmp_ge_u32 s52, 8
    s_cbranch_scc1 K1_NOGX
    ds_read_b128 v[16:19], v73
    ds_read_b128 v[20:23], v73 offset:64
K1_NOGX:
    s_sub_u32 s60, s52, 4
    s_cmp_lt_u32 s60, 8
    s_cbranch_scc1 K1_W0
    s_waitcnt vmcnt(4)
    s_branch K1_W1
K1_W0:
    s_waitcnt vmcnt(0)
K1_W1:
    s_waitcnt lgkmcnt(0)
    s_barrier
    ds_read_b64_tr_b16 v[96:97], v64 offset:0
    ds_read_b64_tr_b16 v[98:99], v64 offset:1024
    ds_read_b64_tr_b16 v[100:101], v64 offset:8192
    ds_read_b64_tr_b16 v[102:103], v64 offset:9216
    ds_read_b64_tr_b16 v[104:105], v64 offset:16384
    ds_read_b64_tr_b16 v[106:107], v64 offset:17408
    ds_read_b64_tr_b16 v[108:109], v64 offset:24576
    ds_read_b64_tr_b16 v[110:111], v64 offset:25600
    ds_read_b64_tr_b16 v[112:113], v64 offset:32768
    ds_read_b64_tr_b16 v[114:115], v64 offset:33792
    ds_read_b64_tr_b16 v[116:117], v64 offset:40960
    ds_read_b64_tr_b16 v[118:119], v64 offset:41984
    ds_read_b64_tr_b16 v[120:121], v64 offset:49152
    ds_read_b64_tr_b16 v[122:123], v64 offset:50176
    ds_read_b64_tr_b16 v[124:125], v64 offset:57344
    ds_read_b64_tr_b16 v[126:127], v64 offset:58368
    s_waitcnt lgkmcnt(14)
    v_mfma_f32_16x16x32_bf16 v[76:79], v[96:99], v[40:43], 0
    s_waitcnt lgkmcnt(12)
    v_mfma_f32_16x16x32_bf16 v[76:79], v[100:103], v[44:47], v[76:79]
    s_waitcnt lgkmcnt(10)
    v_mfma_f32_16x16x32_bf16 v[76:79], v[104:107], v[48:51], v[76:79]
    s_waitcnt lgkmcnt(8)
    v_mfma_f32_16x16x32_bf16 v[76:79], v[108:111], v[52:55], v[76:79]
    s_waitcnt lgkmcnt(6)
    v_mfma_f32_16x16x32_bf16 v[76:79], v[112:115], v[80:83], v[76:79]
    s_waitcnt lgkmcnt(4)
    v_mfma_f32_16x16x32_bf16 v[76:79], v[116:119], v[84:87], v[76:79]
    s_waitcnt lgkmcnt(2)
    v_mfma_f32_16x16x32_bf16 v[76:79], v[120:123], v[88:91], v[76:79]
    s_waitcnt lgkmcnt(0)
    v_mfma_f32_16x16x32_bf16 v[76:79], v[124:127], v[92:95], v[76:79]
    s_cmp_lt_u32 s52, 12
    s_cbranch_scc1 K1_W2
    s_waitcnt vmcnt(0)
K1_W2:
    s_mov_b64 exec, s[72:73]
    s_nop 5
    ds_write_b128 v75, v[76:79]
    s_mov_b64 exec, -1
    s_waitcnt lgkmcnt(0)
    s_barrier
    s_cmp_ge_u32 s52, 12
    s_cbranch_scc1 K1_QA
    s_cmp_ge_u32 s52, 8
    s_cbranch_scc1 K1_FIN
    s_cmp_eq_u32 s56, 0
    s_cbranch_scc1 K1_FIN
    v_mov_b32 v5, 156416
    s_cmp_ge_u32 s52, 4
    s_cbranch_scc1 K1_GUPOLL
    s_waitcnt vmcnt(0)
    v_mov_b32 v6, 1
    s_mov_b64 exec, 1
    ds_add_u32 v5, v6
    s_mov_b64 exec, -1
K1_GUPOLL:
    ds_read_b32 v6, v5
    s_waitcnt lgkmcnt(0)
    v_readfirstlane_b32 s60, v6
    s_cmp_ge_u32 s60, 4
    s_cbranch_scc1 K1_GUGO
    s_sleep 1
    s_branch K1_GUPOLL
K1_GUGO:
    ds_read_b64_tr_b16 v[96:97], v72
    ds_read_b64_tr_b16 v[98:99], v72 offset:512
    ds_read_b64_tr_b16 v[100:101], v72 offset:4096
    ds_read_b64_tr_b16 v[102:103], v72 offset:4608
    s_waitcnt lgkmcnt(2)
    v_mfma_f32_16x16x32_bf16 v[76:79], v[96:99], v[16:19], 0
    s_waitcnt lgkmcnt(0)
    v_mfma_f32_16x16x32_bf16 v[76:79], v[100:103], v[20:23], v[76:79]
    s_mov_b64 exec, s[72:73]
    s_nop 7
    buffer_store_dwordx4 v[76:79], v74, s[48:51], s67 offen sc1
    s_branch K1_FIN
K1_QA:
    s_setprio 3
    s_sub_u32 s70, s52, 12
    s_lshl_b32 s60, s70, 12
    v_add_u32 v5, 0, v2
    v_xor_b32 v6, v5, v3
    v_lshlrev_b32 v5, 8, v5
    v_lshl_add_u32 v5, v6, 4, v5
    v_add_u32 v5, s60, v5
    ds_write_b128 v5, v[24:27]
    v_add_u32 v5, 4, v2
    v_xor_b32 v6, v5, v3
    v_lshlrev_b32 v5, 8, v5
    v_lshl_add_u32 v5, v6, 4, v5
    v_add_u32 v5, s60, v5
    ds_write_b128 v5, v[28:31]
    v_add_u32 v5, 8, v2
    v_xor_b32 v6, v5, v3
    v_lshlrev_b32 v5, 8, v5
    v_lshl_add_u32 v5, v6, 4, v5
    v_add_u32 v5, s60, v5
    ds_write_b128 v5, v[32:35]
    v_add_u32 v5, 12, v2
    v_xor_b32 v6, v5, v3
    v_lshlrev_b32 v5, 8, v5
    v_lshl_add_u32 v5, v6, 4, v5
    v_add_u32 v5, s60, v5
    ds_write_b128 v5, v[36:39]
    v_and_b32 v4, 3, v3
    v_lshlrev_b32 v4, 9, v4
    v_lshl_add_u32 v4, v2, 5, v4
    v_and_b32 v5, 1, v3
    v_lshl_add_u32 v4, v5, 4, v4
    v_bfe_u32 v5, v3, 1, 1
    v_lshl_add_u32 v4, v5, 7, v4
    v_add_u32 v4, 151808, v4
    ds_read_b128 v[40:43], v4 offset:0
    ds_read_b128 v[44:47], v4 offset:16
    ds_read_b128 v[48:51], v4 offset:2304
    ds_read_b128 v[52:55], v4 offset:2320
    ds_read_b128 v[56:59], v4 offset:128
    ds_read_b128 v[60:63], v4 offset:144
    ds_read_b128 v[64:67], v4 offset:2432
    ds_read_b128 v[68:71], v4 offset:2448
    ds_read_b128 v[72:75], v4 offset:256
    ds_read_b128 v[76:79], v4 offset:272
    ds_read_b128 v[80:83], v4 offset:2560
    ds_read_b128 v[84:87], v4 offset:2576
    ds_read_b128 v[88:91], v4 offset:384
    ds_read_b128 v[92:95], v4 offset:400
    ds_read_b128 v[96:99], v4 offset:2688
    ds_read_b128 v[100:103], v4 offset:2704
    v_lshlrev_b32 v5, 8, v3
    v_add_u32 v5, s60, v5
    v_add_u32 v6, 0, v2
    v_xor_b32 v6, v6, v3
    v_lshl_add_u32 v6, v6, 4, v5
    ds_read_b128 v[24:27], v6
    v_add_u32 v6, 4, v2
    v_xor_b32 v6, v6, v3
    v_lshl_add_u32 v6, v6, 4, v5
    ds_read_b128 v[28:31], v6
    v_add_u32 v6, 8, v2
    v_xor_b32 v6, v6, v3
    v_lshl_add_u32 v6, v6, 4, v5
    ds_read_b128 v[32:35], v6
    v_add_u32 v6, 12, v2
    v_xor_b32 v6, v6, v3
    v_lshl_add_u32 v6, v6, 4, v5
    ds_read_b128 v[36:39], v6
    s_lshr_b32 s60, s53, 4
    s_lshl_b32 s60, s60, 4
    s_lshl_b32 s61, s54, 1
    s_add_u32 s60, s60, s61
    s_lshr_b32 s61, s70, 1
    s_add_u32 s60, s60, s61
    s_lshl_b32 s60, s60, 10
    s_and_b32 s61, s70, 1
    s_lshl_b32 s61, s61, 9
    s_add_u32 s60, s60, s61
    s_and_b32 s61, s53, 15
    s_lshl_b32 s61, s61, 4
    s_add_u32 s60, s60, s61
    s_add_u32 s60, s60, 0
    v_lshlrev_b32 v4, 15, v3
    v_lshrrev_b32 v5, 1, v2
    v_lshl_add_u32 v4, v5, 8, v4
    v_and_b32 v5, 1, v2
    v_lshl_add_u32 v4, v5, 3, v4
    s_waitcnt lgkmcnt(4)
    v_add_f32 v40, v40, v48
    v_add_f32 v41, v41, v49
    v_add_f32 v42, v42, v50
    v_add_f32 v43, v43, v51
    v_add_f32 v44, v44, v52
    v_add_f32 v45, v45, v53
    v_add_f32 v46, v46, v54
    v_add_f32 v47, v47, v55
    v_cvt_pk_bf16_f32 v104, v40, v41
    v_cvt_pk_bf16_f32 v105, v42, v43
    v_cvt_pk_bf16_f32 v106, v44, v45
    v_cvt_pk_bf16_f32 v107, v46, v47
    v_add_f32 v56, v56, v64
    v_add_f32 v57, v57, v65
    v_add_f32 v58, v58, v66
    v_add_f32 v59, v59, v67
    v_add_f32 v60, v60, v68
    v_add_f32 v61, v61, v69
    v_add_f32 v62, v62, v70
    v_add_f32 v63, v63, v71
    v_cvt_pk_bf16_f32 v108, v56, v57
    v_cvt_pk_bf16_f32 v109, v58, v59
    v_cvt_pk_bf16_f32 v110, v60, v61
    v_cvt_pk_bf16_f32 v111, v62, v63
    v_add_f32 v72, v72, v80
    v_add_f32 v73, v73, v81
    v_add_f32 v74, v74, v82
    v_add_f32 v75, v75, v83
    v_add_f32 v76, v76, v84
    v_add_f32 v77, v77, v85
    v_add_f32 v78, v78, v86
    v_add_f32 v79, v79, v87
    v_cvt_pk_bf16_f32 v112, v72, v73
    v_cvt_pk_bf16_f32 v113, v74, v75
    v_cvt_pk_bf16_f32 v114, v76, v77
    v_cvt_pk_bf16_f32 v115, v78, v79
    v_add_f32 v88, v88, v96
    v_add_f32 v89, v89, v97
    v_add_f32 v90, v90, v98
    v_add_f32 v91, v91, v99
    v_add_f32 v92, v92, v100
    v_add_f32 v93, v93, v101
    v_add_f32 v94, v94, v102
    v_add_f32 v95, v95, v103
    v_cvt_pk_bf16_f32 v116, v88, v89
    v_cvt_pk_bf16_f32 v117, v90, v91
    v_cvt_pk_bf16_f32 v118, v92, v93
    v_cvt_pk_bf16_f32 v119, v94, v95
    s_waitcnt lgkmcnt(0)
    s_nop 0
    v_mfma_f32_16x16x32_bf16 v[120:123], v[24:27], v[104:107], 0
    v_mfma_f32_16x16x32_bf16 v[120:123], v[28:31], v[108:111], v[120:123]
    v_mfma_f32_16x16x32_bf16 v[120:123], v[32:35], v[112:115], v[120:123]
    v_mfma_f32_16x16x32_bf16 v[120:123], v[36:39], v[116:119], v[120:123]
    s_nop 7
    v_cvt_pk_bf16_f32 v124, v120, v121
    v_cvt_pk_bf16_f32 v125, v122, v123
    s_mov_b64 exec, s[72:73]
    buffer_store_dwordx2 v[124:125], v4, s[48:51], s60 offen sc1
K1_FIN:
K1_END:
    s_endpgm
.globl k2_kernel
.p2align 8
.type k2_kernel,@function
k2_kernel:
    s_cmp_ge_u32 s2, 256
    s_cbranch_scc1 K2_END
    s_load_dwordx2 s[4:5], s[0:1], 8
    s_load_dwordx2 s[22:23], s[0:1], 32
    s_load_dwordx2 s[20:21], s[0:1], 104
    v_and_b32 v1, 63, v0
    v_lshrrev_b32 v4, 6, v0
    v_lshrrev_b32 v2, 4, v1
    v_and_b32 v3, 15, v1
    v_readfirstlane_b32 s52, v4
    v_lshlrev_b32 v11, 4, v1
    s_and_b32 s57, s2, 7
    s_lshr_b32 s58, s2, 3
    s_and_b32 s53, s58, 1
    s_lshr_b32 s58, s58, 1
    s_lshl_b32 s57, s57, 4
    s_add_u32 s58, s58, s57
    s_lshr_b32 s54, s58, 5
    s_and_b32 s59, s52, 1
    s_lshl_b32 s59, s59, 7
    v_xor_b32 v12, s59, v11
    v_xor_b32 v13, 32, v12
    v_xor_b32 v14, 64, v12
    v_xor_b32 v15, 96, v12
    s_lshl_b32 s60, s58, 17
    s_lshl_b32 s61, s52, 13
    s_add_u32 s60, s60, s61
    s_lshl_b32 s63, s54, 1
    s_add_u32 s63, s63, s53
    s_lshl_b32 s63, s63, 14
    s_lshl_b32 s64, s52, 10
    s_add_u32 s63, s63, s64
    s_add_u32 s63, s63, 0
    s_waitcnt lgkmcnt(0)
    s_mov_b32 s24, s4
    s_and_b32 s25, s5, 0xffff
    s_mov_b32 s26, 0x1000000
    s_mov_b32 s27, 0x00020000
    s_mov_b32 s48, s20
    s_and_b32 s49, s21, 0xffff
    s_mov_b32 s50, 0xd18000
    s_mov_b32 s51, 0x00020000
    s_add_u32 m0, s64, 131072
    s_nop 0
    buffer_load_dwordx4 v11, s[48:51], s63 offen lds
    s_add_u32 m0, s61, 0
    s_add_u32 s62, s60, 0
    buffer_load_dwordx4 v12, s[24:27], s62 offen lds
    s_add_u32 m0, s61, 1024
    s_add_u32 s62, s60, 1024
    buffer_load_dwordx4 v13, s[24:27], s62 offen lds
    s_add_u32 m0, s61, 2048
    s_add_u32 s62, s60, 2048
    buffer_load_dwordx4 v14, s[24:27], s62 offen lds
    s_add_u32 m0, s61, 3072
    s_add_u32 s62, s60, 3072
    buffer_load_dwordx4 v15, s[24:27], s62 offen lds
    s_add_u32 m0, s61, 4096
    s_add_u32 s62, s60, 4096
    buffer_load_dwordx4 v12, s[24:27], s62 offen lds
    s_add_u32 m0, s61, 5120
    s_add_u32 s62, s60, 5120
    buffer_load_dwordx4 v13, s[24:27], s62 offen lds
    s_add_u32 m0, s61, 6144
    s_add_u32 s62, s60, 6144
    buffer_load_dwordx4 v14, s[24:27], s62 offen lds
    s_add_u32 m0, s61, 7168
    s_add_u32 s62, s60, 7168
    buffer_load_dwordx4 v15, s[24:27], s62 offen lds
    s_cmp_lg_u32 s52, 15
    s_cbranch_scc1 K2_NODN
    v_and_b32 v4, 7, v1
    v_min_u32 v4, 6, v4
    v_bfe_u32 v5, v1, 3, 1
    v_mul_u32_u24 v5, 1792, v5
    v_add_u32 v4, v4, v5
    v_mul_u32_u24 v5, 3584, v2
    v_add_u32 v4, v4, v5
    v_lshlrev_b32 v4, 2, v4
    s_mul_i32 s65, s2, 28
    s_add_u32 s65, s65, 8585216
    s_add_u32 s66, s65, 0
    buffer_load_dword v108, v4, s[48:51], s66 offen
    s_add_u32 s66, s65, 57344
    buffer_load_dword v109, v4, s[48:51], s66 offen
    s_add_u32 s66, s65, 114688
    buffer_load_dword v110, v4, s[48:51], s66 offen
    s_add_u32 s66, s65, 172032
    buffer_load_dword v111, v4, s[48:51], s66 offen
    s_add_u32 s66, s65, 229376
    buffer_load_dword v112, v4, s[48:51], s66 offen
    s_add_u32 s66, s65, 286720
    buffer_load_dword v113, v4, s[48:51], s66 offen
    s_add_u32 s66, s65, 344064
    buffer_load_dword v114, v4, s[48:51], s66 offen
    s_add_u32 s66, s65, 401408
    buffer_load_dword v115, v4, s[48:51], s66 offen
K2_NODN:
    v_and_b32 v4, 8, v3
    v_and_b32 v5, 3, v3
    v_lshl_or_b32 v4, v5, 1, v4
    v_and_b32 v5, 2, v4
    v_xor_b32 v5, v5, v2
    v_and_b32 v4, 12, v4
    v_lshlrev_b32 v6, 10, v3
    v_lshl_add_u32 v6, v5, 4, v6
    s_lshl_b32 s61, s52, 14
    v_add_u32 v6, s61, v6
    v_xor_b32 v7, 0, v4
    v_lshl_add_u32 v20, v7, 4, v6
    v_xor_b32 v7, 4, v4
    v_lshl_add_u32 v21, v7, 4, v6
    v_xor_b32 v7, 8, v4
    v_lshl_add_u32 v22, v7, 4, v6
    v_xor_b32 v7, 12, v4
    v_lshl_add_u32 v23, v7, 4, v6
    v_bfe_u32 v4, v1, 2, 2
    v_and_b32 v5, 3, v1
    v_lshl_add_u32 v6, v2, 3, v4
    v_lshlrev_b32 v6, 10, v6
    v_and_b32 v8, 1, v5
    v_lshl_add_u32 v6, v8, 3, v6
    v_and_b32 v7, 1, v2
    v_lshlrev_b32 v7, 3, v7
    v_lshl_or_b32 v7, v4, 1, v7
    v_lshrrev_b32 v8, 1, v5
    s_lshl_b32 s62, s52, 2
    v_add_u32 v8, s62, v8
    v_add_u32 v9, 0, v8
    v_xor_b32 v9, v9, v7
    v_lshl_add_u32 v24, v9, 4, v6
    v_add_u32 v26, 0x10000, v24
    v_add_u32 v9, 2, v8
    v_xor_b32 v9, v9, v7
    v_lshl_add_u32 v25, v9, 4, v6
    v_add_u32 v27, 0x10000, v25
    v_lshlrev_b32 v38, 5, v3
    s_mov_b32 s63, 0x3db504f3
    s_mov_b32 s64, 0x3fb8aa3b
    s_cmp_eq_u32 s52, 15
    s_cbranch_scc1 K2_W15
    s_waitcnt vmcnt(8)
    s_barrier
    s_cmp_ge_u32 s52, 8
    s_cbranch_scc1 K2_NOPRE
    v_add_u32 v4, 131072, v11
    ds_read_b128 v[64:67], v4 offset:0
    ds_read_b128 v[68:71], v4 offset:1024
    ds_read_b128 v[72:75], v4 offset:2048
    ds_read_b128 v[76:79], v4 offset:3072
    ds_read_b128 v[80:83], v4 offset:4096
    ds_read_b128 v[84:87], v4 offset:5120
    ds_read_b128 v[88:91], v4 offset:6144
    ds_read_b128 v[92:95], v4 offset:7168
    ds_read_b128 v[96:99], v4 offset:8192
    ds_read_b128 v[100:103], v4 offset:9216
    ds_read_b128 v[104:107], v4 offset:10240
    ds_read_b128 v[108:111], v4 offset:11264
    ds_read_b128 v[112:115], v4 offset:12288
    ds_read_b128 v[116:119], v4 offset:13312
    ds_read_b128 v[120:123], v4 offset:14336
    ds_read_b128 v[124:127], v4 offset:15360
K2_NOPRE:
    s_waitcnt vmcnt(0)
    s_branch K2_BARA
K2_W15:
    s_waitcnt vmcnt(16)
    s_barrier
    s_waitcnt vmcnt(8)
K2_BARA:
    s_barrier
    s_cmp_ge_u32 s52, 8
    s_cbranch_scc1 K2_NOQK
    ds_read_b128 v[40:43], v20 offset:0
    ds_read_b128 v[44:47], v21 offset:0
    ds_read_b128 v[48:51], v22 offset:0
    ds_read_b128 v[52:55], v23 offset:0
    ds_read_b128 v[56:59], v20 offset:256
    ds_read_b128 v[60:63], v21 offset:256
    s_waitcnt lgkmcnt(5)
    v_mfma_f32_16x16x32_bf16 v[32:35], v[40:43], v[64:67], 0
    s_nop 0
    ds_read_b128 v[40:43], v22 offset:256
    s_waitcnt lgkmcnt(5)
    v_mfma_f32_16x16x32_bf16 v[32:35], v[44:47], v[68:71], v[32:35]
    s_nop 0
    ds_read_b128 v[44:47], v23 offset:256
    s_waitcnt lgkmcnt(5)
    v_mfma_f32_16x16x32_bf16 v[32:35], v[48:51], v[72:75], v[32:35]
    s_nop 0
    ds_read_b128 v[48:51], v20 offset:512
    s_waitcnt lgkmcnt(5)
    v_mfma_f32_16x16x32_bf16 v[32:35], v[52:55], v[76:79], v[32:35]
    s_nop 0
    ds_read_b128 v[52:55], v21 offset:512
    s_waitcnt lgkmcnt(5)
    v_mfma_f32_16x16x32_bf16 v[32:35], v[56:59], v[80:83], v[32:35]
    s_nop 0
    ds_read_b128 v[56:59], v22 offset:512
    s_waitcnt lgkmcnt(5)
    v_mfma_f32_16x16x32_bf16 v[32:35], v[60:63], v[84:87], v[32:35]
    s_nop 0
    ds_read_b128 v[60:63], v23 offset:512
    s_waitcnt lgkmcnt(5)
    v_mfma_f32_16x16x32_bf16 v[32:35], v[40:43], v[88:91], v[32:35]
    s_nop 0
    ds_read_b128 v[40:43], v20 offset:768
    s_waitcnt lgkmcnt(5)
    v_mfma_f32_16x16x32_bf16 v[32:35], v[44:47], v[92:95], v[32:35]
    s_nop 0
    ds_read_b128 v[44:47], v21 offset:768
    s_waitcnt lgkmcnt(5)
    v_mfma_f32_16x16x32_bf16 v[32:35], v[48:51], v[96:99], v[32:35]
    s_nop 0
    ds_read_b128 v[48:51], v22 offset:768
    s_waitcnt lgkmcnt(5)
    v_mfma_f32_16x16x32_bf16 v[32:35], v[52:55], v[100:103], v[32:35]
    s_nop 0
    ds_read_b128 v[52:55], v23 offset:768
    s_waitcnt lgkmcnt(5)
    v_mfma_f32_16x16x32_bf16 v[32:35], v[56:59], v[104:107], v[32:35]
    s_waitcnt lgkmcnt(4)
    v_mfma_f32_16x16x32_bf16 v[32:35], v[60:63], v[108:111], v[32:35]
    s_waitcnt lgkmcnt(3)
    v_mfma_f32_16x16x32_bf16 v[32:35], v[40:43], v[112:115], v[32:35]
    s_waitcnt lgkmcnt(2)
    v_mfma_f32_16x16x32_bf16 v[32:35], v[44:47], v[116:119], v[32:35]
    s_waitcnt lgkmcnt(1)
    v_mfma_f32_16x16x32_bf16 v[32:35], v[48:51], v[120:123], v[32:35]
    s_waitcnt lgkmcnt(0)
    v_mfma_f32_16x16x32_bf16 v[32:35], v[52:55], v[124:127], v[32:35]
    s_nop 7
    v_cvt_pk_bf16_f32 v32, v32, v32
    v_and_b32 v32, 0xffff0000, v32
    v_mul_f32 v32, s63, v32
    v_cvt_pk_bf16_f32 v32, v32, v32
    v_and_b32 v32, 0xffff0000, v32
    v_cvt_pk_bf16_f32 v33, v33, v33
    v_and_b32 v33, 0xffff0000, v33
    v_mul_f32 v33, s63, v33
    v_cvt_pk_bf16_f32 v33, v33, v33
    v_and_b32 v33, 0xffff0000, v33
    v_cvt_pk_bf16_f32 v34, v34, v34
    v_and_b32 v34, 0xffff0000, v34
    v_mul_f32 v34, s63, v34
    v_cvt_pk_bf16_f32 v34, v34, v34
    v_and_b32 v34, 0xffff0000, v34
    v_cvt_pk_bf16_f32 v35, v35, v35
    v_and_b32 v35, 0xffff0000, v35
    v_mul_f32 v35, s63, v35
    v_cvt_pk_bf16_f32 v35, v35, v35
    v_and_b32 v35, 0xffff0000, v35
    v_max_f32 v36, v32, v33
    v_max3_f32 v36, v36, v34, v35
    v_mov_b32 v37, v36
    s_nop 1
    v_permlane32_swap_b32 v36, v37
    s_nop 1
    v_max_f32 v36, v36, v37
    v_mov_b32 v37, v36
    s_nop 1
    v_permlane16_swap_b32 v36, v37
    s_nop 1
    v_max_f32 v36, v36, v37
    s_lshl_b32 s62, s52, 2
    s_add_u32 s62, s62, 151552
    v_add_u32 v39, s62, v38
    ds_write_b32 v39, v36
    s_waitcnt lgkmcnt(0)
    s_barrier
    v_add_u32 v39, 151552, v38
    ds_read_b128 v[40:43], v39
    ds_read_b128 v[44:47], v39 offset:16
    s_waitcnt lgkmcnt(0)
    v_max3_f32 v40, v40, v41, v42
    v_max3_f32 v44, v44, v45, v46
    v_max3_f32 v40, v40, v43, v47
    v_max_f32 v40, v40, v44
    v_sub_f32 v32, v32, v40
    v_mul_f32 v32, s64, v32
    v_exp_f32 v32, v32
    v_sub_f32 v33, v33, v40
    v_mul_f32 v33, s64, v33
    v_exp_f32 v33, v33
    v_sub_f32 v34, v34, v40
    v_mul_f32 v34, s64, v34
    v_exp_f32 v34, v34
    v_sub_f32 v35, v35, v40
    v_mul_f32 v35, s64, v35
    v_exp_f32 v35, v35
    s_nop 0
    v_add_f32 v36, v32, v33
    v_add_f32 v37, v34, v35
    v_add_f32 v36, v36, v37
    v_cvt_pk_bf16_f32 v42, v32, v33
    v_cvt_pk_bf16_f32 v43, v34, v35
    s_lshl_b32 s62, s52, 9
    s_add_u32 s62, s62, 147456
    v_lshrrev_b32 v44, 1, v2
    v_lshlrev_b32 v44, 8, v44
    v_lshl_add_u32 v44, v3, 4, v44
    v_and_b32 v45, 1, v2
    v_lshl_add_u32 v44, v45, 3, v44
    v_add_u32 v44, s62, v44
    ds_write_b64 v44, v[42:43]
    v_mov_b32 v37, v36
    s_nop 1
    v_permlane32_swap_b32 v36, v37
    s_nop 1
    v_add_f32 v36, v36, v37
    v_mov_b32 v37, v36
    s_nop 1
    v_permlane16_swap_b32 v36, v37
    s_nop 1
    v_add_f32 v36, v36, v37
    s_lshl_b32 s62, s52, 2
    s_add_u32 s62, s62, 152064
    v_add_u32 v39, s62, v38
    ds_write_b32 v39, v36
    s_branch K2_PV0
K2_NOQK:
    s_cmp_lg_u32 s52, 15
    s_cbranch_scc1 K2_NOHH
    s_waitcnt vmcnt(0)
    v_add_f32 v108, v108, v109
    v_add_f32 v108, v108, v110
    v_add_f32 v108, v108, v111
    v_add_f32 v108, v108, v112
    v_add_f32 v108, v108, v113
    v_add_f32 v108, v108, v114
    v_add_f32 v108, v108, v115
    v_cvt_pk_bf16_f32 v108, v108, v108
    v_and_b32 v108, 0xffff0000, v108
    v_mov_b32 v109, v108
    s_nop 1
    v_mov_b32_dpp v109, v108 row_shl:8 row_mask:0xf bank_mask:0xf
    v_mul_f32 v110, 0xbfb8aa3b, v108
    v_exp_f32 v110, v110
    s_nop 0
    v_add_f32 v110, 1.0, v110
    v_rcp_f32 v110, v110
    s_nop 0
    v_mul_f32 v108, v108, v110
    v_cvt_pk_bf16_f32 v108, v108, v108
    v_and_b32 v108, 0xffff0000, v108
    v_mul_f32 v108, v108, v109
    v_cvt_pk_bf16_f32 v108, v108, v108
    v_cmp_gt_u32 vcc, 7, v3
    s_nop 1
    v_cndmask_b32 v108, 0, v108, vcc
    v_lshlrev_b32 v109, 1, v1
    s_lshl_b32 s65, s2, 7
    s_add_u32 s65, s65, 13697024
    buffer_store_short v108, v109, s[48:51], s65 offen sc1
K2_NOHH:
    s_barrier
K2_PV0:
    ds_read_b64_tr_b16 v[64:65], v24 offset:0
    ds_read_b64_tr_b16 v[66:67], v24 offset:4096
    ds_read_b64_tr_b16 v[68:69], v25 offset:0
    ds_read_b64_tr_b16 v[70:71], v25 offset:4096
    ds_read_b64_tr_b16 v[72:73], v24 offset:32768
    ds_read_b64_tr_b16 v[74:75], v24 offset:36864
    ds_read_b64_tr_b16 v[76:77], v25 offset:32768
    ds_read_b64_tr_b16 v[78:79], v25 offset:36864
    ds_read_b64_tr_b16 v[80:81], v26 offset:0
    ds_read_b64_tr_b16 v[82:83], v26 offset:4096
    ds_read_b64_tr_b16 v[84:85], v27 offset:0
    ds_read_b64_tr_b16 v[86:87], v27 offset:4096
    ds_read_b64_tr_b16 v[88:89], v26 offset:32768
    ds_read_b64_tr_b16 v[90:91], v26 offset:36864
    ds_read_b64_tr_b16 v[92:93], v27 offset:32768
    ds_read_b64_tr_b16 v[94:95], v27 offset:36864
    s_waitcnt lgkmcnt(0)
    s_barrier
    v_add_u32 v4, 147456, v11
    ds_read_b128 v[48:51], v4 offset:0
    ds_read_b128 v[52:55], v4 offset:1024
    ds_read_b128 v[56:59], v4 offset:2048
    ds_read_b128 v[60:63], v4 offset:3072
    s_waitcnt lgkmcnt(3)
    v_mfma_f32_16x16x32_bf16 v[96:99], v[64:67], v[48:51], 0
    v_mfma_f32_16x16x32_bf16 v[100:103], v[68:71], v[48:51], 0
    s_waitcnt lgkmcnt(2)
    v_mfma_f32_16x16x32_bf16 v[96:99], v[72:75], v[52:55], v[96:99]
    v_mfma_f32_16x16x32_bf16 v[100:103], v[76:79], v[52:55], v[100:103]
    s_waitcnt lgkmcnt(1)
    v_mfma_f32_16x16x32_bf16 v[96:99], v[80:83], v[56:59], v[96:99]
    v_mfma_f32_16x16x32_bf16 v[100:103], v[84:87], v[56:59], v[100:103]
    s_waitcnt lgkmcnt(0)
    v_mfma_f32_16x16x32_bf16 v[96:99], v[88:91], v[60:63], v[96:99]
    v_mfma_f32_16x16x32_bf16 v[100:103], v[92:95], v[60:63], v[100:103]
    v_mul_u32_u24 v4, 1040, v3
    v_lshl_add_u32 v4, v2, 3, v4
    s_lshl_b32 s61, s52, 6
    s_add_u32 s61, s61, 0
    v_add_u32 v4, s61, v4
    s_nop 2
    v_cvt_pk_bf16_f32 v104, v96, v97
    v_cvt_pk_bf16_f32 v105, v98, v99
    ds_write_b64 v4, v[104:105] offset:0
    v_cvt_pk_bf16_f32 v106, v100, v101
    v_cvt_pk_bf16_f32 v107, v102, v103
    ds_write_b64 v4, v[106:107] offset:32
    s_mul_i32 s61, s52, 1040
    s_add_u32 s61, s61, 0
    v_add_u32 v4, s61, v11
    s_lshl_b32 s60, s53, 4
    s_add_u32 s60, s60, s52
    s_lshl_b32 s60, s60, 17
    s_lshl_b32 s61, s58, 10
    s_add_u32 s60, s60, s61
    s_add_u32 s60, s60, 196608
    s_waitcnt lgkmcnt(0)
    s_barrier
    ds_read_b128 v[104:107], v4
    s_waitcnt lgkmcnt(0)
    buffer_store_dwordx4 v[104:107], v11, s[48:51], s60 offen sc1
    s_cmp_lg_u32 s52, 0
    s_cbranch_scc1 K2_FIN
    v_add_u32 v39, 152064, v38
    ds_read_b128 v[88:91], v39
    ds_read_b128 v[92:95], v39 offset:16
    s_waitcnt lgkmcnt(0)
    v_add_f32 v88, v88, v89
    v_add_f32 v90, v90, v91
    v_add_f32 v92, v92, v93
    v_add_f32 v94, v94, v95
    v_add_f32 v88, v88, v90
    v_add_f32 v92, v92, v94
    v_add_f32 v41, v88, v92
    s_lshl_b32 s60, s53, 14
    s_lshl_b32 s61, s58, 3
    s_add_u32 s60, s60, s61
    s_add_u32 s60, s60, 155648
    v_lshlrev_b32 v4, 10, v3
    v_cmp_gt_u32 vcc, 16, v1
    s_and_saveexec_b64 s[72:73], vcc
    buffer_store_dwordx2 v[40:41], v4, s[48:51], s60 offen sc1
K2_FIN:
K2_END:
    s_endpgm
.globl k3_kernel
.p2align 8
.type k3_kernel,@function
k3_kernel:
    s_cmp_ge_u32 s2, 256
    s_cbranch_scc1 K3_END
    s_load_dwordx4 s[8:11], s[0:1], 32
    s_load_dwordx2 s[12:13], s[0:1], 80
    s_load_dwordx2 s[20:21], s[0:1], 104
    v_and_b32 v1, 63, v0
    v_lshrrev_b32 v4, 6, v0
    v_lshrrev_b32 v2, 4, v1
    v_and_b32 v3, 15, v1
    v_readfirstlane_b32 s52, v4
    v_lshlrev_b32 v11, 4, v1
    v_and_b32 v14, 3, v3
    v_lshlrev_b32 v14, 5, v14
    v_lshl_add_u32 v14, v2, 3, v14
    v_cmp_gt_u32 vcc, 4, v3
    s_mov_b64 s[72:73], vcc
    s_and_b32 s57, s2, 7
    s_lshr_b32 s58, s2, 3
    s_and_b32 s59, s58, 3
    s_lshl_b32 s53, s57, 2
    s_add_u32 s53, s53, s59
    s_lshr_b32 s54, s58, 2
    s_lshl_b32 s69, s54, 1
    s_add_u32 s69, s69, s52
    s_and_b32 s69, s69, 15
    s_lshr_b32 s55, s69, 2
    s_lshl_b32 s60, s53, 2
    s_add_u32 s60, s60, s55
    v_lshlrev_b32 v12, 10, v2
    v_lshl_add_u32 v12, v3, 4, v12
    v_and_b32 v4, 31, v1
    v_lshlrev_b32 v4, 3, v4
    s_waitcnt lgkmcnt(0)
    s_mov_b32 s48, s20
    s_and_b32 s49, s21, 0xffff
    s_mov_b32 s50, 0xd18000
    s_mov_b32 s51, 0x00020000
    s_mov_b32 s28, s10
    s_and_b32 s29, s11, 0xffff
    s_mov_b32 s30, 0x400000
    s_mov_b32 s31, 0x00020000
    s_mov_b32 s32, s12
    s_and_b32 s33, s13, 0xffff
    s_mov_b32 s34, 0x1c0000
    s_mov_b32 s35, 0x00020000
    s_cmp_ge_u32 s52, 4
    s_cbranch_scc1 K3_NOUVT
    s_lshl_b32 s70, s52, 12
    s_mov_b32 s24, s8
    s_and_b32 s25, s9, 0xffff
    s_mov_b32 s26, 0x400000
    s_mov_b32 s27, 0x00020000
    v_lshrrev_b32 v6, 1, v1
    v_lshlrev_b32 v6, 13, v6
    v_and_b32 v7, 1, v1
    v_lshl_add_u32 v6, v7, 4, v6
    s_lshl_b32 s61, s52, 20
    s_lshl_b32 s63, s53, 8
    s_add_u32 s61, s61, s63
    s_lshl_b32 s63, s54, 5
    s_add_u32 s61, s61, s63
    s_add_u32 m0, s70, 0
    s_add_u32 s63, s61, 0
    buffer_load_dwordx4 v6, s[24:27], s63 offen lds
    s_add_u32 m0, s70, 1024
    s_add_u32 s63, s61, 262144
    buffer_load_dwordx4 v6, s[24:27], s63 offen lds
    s_add_u32 m0, s70, 2048
    s_add_u32 s63, s61, 524288
    buffer_load_dwordx4 v6, s[24:27], s63 offen lds
    s_add_u32 m0, s70, 3072
    s_add_u32 s63, s61, 786432
    buffer_load_dwordx4 v6, s[24:27], s63 offen lds
K3_NOUVT:
    s_lshl_b32 s61, s60, 8
    s_add_u32 s61, s61, 155648
    buffer_load_dwordx2 v[16:17], v4, s[48:51], s61 offen
    s_lshl_b32 s65, s2, 7
    s_add_u32 s65, s65, 13697024
    buffer_load_dwordx2 v[22:23], v14, s[48:51], s65 offen
    s_lshl_b32 s61, s60, 15
    s_and_b32 s62, s69, 3
    s_lshl_b32 s63, s62, 8
    s_add_u32 s61, s61, s63
    s_add_u32 s61, s61, 196608
    s_add_u32 s63, s61, 0
    buffer_load_dwordx4 v[64:67], v12, s[48:51], s63 offen
    s_add_u32 s63, s61, 4096
    buffer_load_dwordx4 v[68:71], v12, s[48:51], s63 offen
    s_add_u32 s63, s61, 8192
    buffer_load_dwordx4 v[72:75], v12, s[48:51], s63 offen
    s_add_u32 s63, s61, 12288
    buffer_load_dwordx4 v[76:79], v12, s[48:51], s63 offen
    s_add_u32 s63, s61, 16384
    buffer_load_dwordx4 v[80:83], v12, s[48:51], s63 offen
    s_add_u32 s63, s61, 20480
    buffer_load_dwordx4 v[84:87], v12, s[48:51], s63 offen
    s_add_u32 s63, s61, 24576
    buffer_load_dwordx4 v[88:91], v12, s[48:51], s63 offen
    s_add_u32 s63, s61, 28672
    buffer_load_dwordx4 v[92:95], v12, s[48:51], s63 offen
    s_cmp_lt_u32 s52, 12
    s_cbranch_scc1 K3_NOCOLD
    s_sub_u32 s71, s52, 12
    s_lshl_b32 s70, s71, 12
    s_lshl_b32 s61, s53, 7
    s_lshl_b32 s63, s54, 4
    s_add_u32 s61, s61, s63
    s_lshl_b32 s63, s71, 2
    s_add_u32 s61, s61, s63
    s_lshl_b32 s61, s61, 10
    s_and_b32 s63, s71, 1
    s_lshl_b32 s63, s63, 7
    s_add_u32 s64, s63, 0
    v_xor_b32 v6, s64, v11
    s_add_u32 m0, s70, 16384
    s_add_u32 s65, s61, 0
    buffer_load_dwordx4 v6, s[28:31], s65 offen lds
    s_add_u32 s64, s63, 32
    v_xor_b32 v6, s64, v11
    s_add_u32 m0, s70, 17408
    s_add_u32 s65, s61, 1024
    buffer_load_dwordx4 v6, s[28:31], s65 offen lds
    s_add_u32 s64, s63, 64
    v_xor_b32 v6, s64, v11
    s_add_u32 m0, s70, 18432
    s_add_u32 s65, s61, 2048
    buffer_load_dwordx4 v6, s[28:31], s65 offen lds
    s_add_u32 s64, s63, 96
    v_xor_b32 v6, s64, v11
    s_add_u32 m0, s70, 19456
    s_add_u32 s65, s61, 3072
    buffer_load_dwordx4 v6, s[28:31], s65 offen lds
    s_mul_i32 s65, s2, 7168
    s_lshl_b32 s66, s71, 1
    s_add_u32 s66, s66, 0
    s_min_u32 s66, s66, 6
    s_lshl_b32 s67, s66, 5
    v_xor_b32 v6, s67, v11
    s_lshl_b32 s66, s66, 10
    s_add_u32 m0, s66, 38144
    s_add_u32 s66, s66, s65
    buffer_load_dwordx4 v6, s[32:35], s66 offen lds
    s_lshl_b32 s66, s71, 1
    s_add_u32 s66, s66, 1
    s_min_u32 s66, s66, 6
    s_lshl_b32 s67, s66, 5
    v_xor_b32 v6, s67, v11
    s_lshl_b32 s66, s66, 10
    s_add_u32 m0, s66, 38144
    s_add_u32 s66, s66, s65
    buffer_load_dwordx4 v6, s[32:35], s66 offen lds
K3_NOCOLD:
    v_lshlrev_b32 v13, 2, v2
    s_cmp_lt_u32 s52, 12
    s_cbranch_scc1 K3_CB
    s_waitcnt vmcnt(14)
    v_mov_b32 v18, v16
    s_nop 1
    v_max_f32_dpp v18, v18, v18 row_shr:1 row_mask:0xf bank_mask:0xf
    s_nop 1
    v_max_f32_dpp v18, v18, v18 row_shr:2 row_mask:0xf bank_mask:0xf
    s_nop 1
    v_max_f32_dpp v18, v18, v18 row_shr:4 row_mask:0xf bank_mask:0xf
    s_nop 1
    v_max_f32_dpp v18, v18, v18 row_shr:8 row_mask:0xf bank_mask:0xf
    s_nop 1
    v_readlane_b32 s64, v18, 15
    v_readlane_b32 s65, v18, 31
    s_nop 1
    v_mov_b32 v18, s64
    v_max_f32 v18, s65, v18
    v_sub_f32 v19, v16, v18
    v_mul_f32 v19, 0x3fb8aa3b, v19
    v_exp_f32 v19, v19
    s_nop 0
    v_mul_f32 v20, v19, v17
    s_nop 1
    v_add_f32_dpp v20, v20, v20 row_shr:1 row_mask:0xf bank_mask:0xf bound_ctrl:0
    s_nop 1
    v_add_f32_dpp v20, v20, v20 row_shr:2 row_mask:0xf bank_mask:0xf bound_ctrl:0
    s_nop 1
    v_add_f32_dpp v20, v20, v20 row_shr:4 row_mask:0xf bank_mask:0xf bound_ctrl:0
    s_nop 1
    v_add_f32_dpp v20, v20, v20 row_shr:8 row_mask:0xf bank_mask:0xf bound_ctrl:0
    s_nop 1
    v_readlane_b32 s64, v20, 15
    v_readlane_b32 s65, v20, 31
    s_nop 1
    v_mov_b32 v20, s64
    v_add_f32 v20, s65, v20
    v_rcp_f32 v20, v20
    s_nop 0
    v_mul_f32 v19, v19, v20
    ds_bpermute_b32 v96, v13, v19 offset:0
    ds_bpermute_b32 v98, v13, v19 offset:16
    ds_bpermute_b32 v100, v13, v19 offset:32
    ds_bpermute_b32 v102, v13, v19 offset:48
    ds_bpermute_b32 v104, v13, v19 offset:64
    ds_bpermute_b32 v106, v13, v19 offset:80
    ds_bpermute_b32 v108, v13, v19 offset:96
    ds_bpermute_b32 v110, v13, v19 offset:112
    s_waitcnt vmcnt(13) lgkmcnt(7)
    v_lshlrev_b32 v40, 16, v64
    v_and_b32 v41, 0xffff0000, v64
    v_pk_mul_f32 v[24:25], v[40:41], v[96:97] op_sel_hi:[1,0]
    v_lshlrev_b32 v42, 16, v65
    v_and_b32 v43, 0xffff0000, v65
    v_pk_mul_f32 v[26:27], v[42:43], v[96:97] op_sel_hi:[1,0]
    v_lshlrev_b32 v40, 16, v66
    v_and_b32 v41, 0xffff0000, v66
    v_pk_mul_f32 v[28:29], v[40:41], v[96:97] op_sel_hi:[1,0]
    v_lshlrev_b32 v42, 16, v67
    v_and_b32 v43, 0xffff0000, v67
    v_pk_mul_f32 v[30:31], v[42:43], v[96:97] op_sel_hi:[1,0]
    s_waitcnt vmcnt(12) lgkmcnt(6)
    v_lshlrev_b32 v40, 16, v68
    v_and_b32 v41, 0xffff0000, v68
    v_pk_fma_f32 v[24:25], v[40:41], v[98:99], v[24:25] op_sel_hi:[1,0,1]
    v_lshlrev_b32 v42, 16, v69
    v_and_b32 v43, 0xffff0000, v69
    v_pk_fma_f32 v[26:27], v[42:43], v[98:99], v[26:27] op_sel_hi:[1,0,1]
    v_lshlrev_b32 v40, 16, v70
    v_and_b32 v41, 0xffff0000, v70
    v_pk_fma_f32 v[28:29], v[40:41], v[98:99], v[28:29] op_sel_hi:[1,0,1]
    v_lshlrev_b32 v42, 16, v71
    v_and_b32 v43, 0xffff0000, v71
    v_pk_fma_f32 v[30:31], v[42:43], v[98:99], v[30:31] op_sel_hi:[1,0,1]
    s_waitcnt vmcnt(11) lgkmcnt(5)
    v_lshlrev_b32 v40, 16, v72
    v_and_b32 v41, 0xffff0000, v72
    v_pk_fma_f32 v[24:25], v[40:41], v[100:101], v[24:25] op_sel_hi:[1,0,1]
    v_lshlrev_b32 v42, 16, v73
    v_and_b32 v43, 0xffff0000, v73
    v_pk_fma_f32 v[26:27], v[42:43], v[100:101], v[26:27] op_sel_hi:[1,0,1]
    v_lshlrev_b32 v40, 16, v74
    v_and_b32 v41, 0xffff0000, v74
    v_pk_fma_f32 v[28:29], v[40:41], v[100:101], v[28:29] op_sel_hi:[1,0,1]
    v_lshlrev_b32 v42, 16, v75
    v_and_b32 v43, 0xffff0000, v75
    v_pk_fma_f32 v[30:31], v[42:43], v[100:101], v[30:31] op_sel_hi:[1,0,1]
    s_waitcnt vmcnt(10) lgkmcnt(4)
    v_lshlrev_b32 v40, 16, v76
    v_and_b32 v41, 0xffff0000, v76
    v_pk_fma_f32 v[24:25], v[40:41], v[102:103], v[24:25] op_sel_hi:[1,0,1]
    v_lshlrev_b32 v42, 16, v77
    v_and_b32 v43, 0xffff0000, v77
    v_pk_fma_f32 v[26:27], v[42:43], v[102:103], v[26:27] op_sel_hi:[1,0,1]
    v_lshlrev_b32 v40, 16, v78
    v_and_b32 v41, 0xffff0000, v78
    v_pk_fma_f32 v[28:29], v[40:41], v[102:103], v[28:29] op_sel_hi:[1,0,1]
    v_lshlrev_b32 v42, 16, v79
    v_and_b32 v43, 0xffff0000, v79
    v_pk_fma_f32 v[30:31], v[42:43], v[102:103], v[30:31] op_sel_hi:[1,0,1]
    s_waitcnt vmcnt(9) lgkmcnt(3)
    v_lshlrev_b32 v40, 16, v80
    v_and_b32 v41, 0xffff0000, v80
    v_pk_fma_f32 v[24:25], v[40:41], v[104:105], v[24:25] op_sel_hi:[1,0,1]
    v_lshlrev_b32 v42, 16, v81
    v_and_b32 v43, 0xffff0000, v81
    v_pk_fma_f32 v[26:27], v[42:43], v[104:105], v[26:27] op_sel_hi:[1,0,1]
    v_lshlrev_b32 v40, 16, v82
    v_and_b32 v41, 0xffff0000, v82
    v_pk_fma_f32 v[28:29], v[40:41], v[104:105], v[28:29] op_sel_hi:[1,0,1]
    v_lshlrev_b32 v42, 16, v83
    v_and_b32 v43, 0xffff0000, v83
    v_pk_fma_f32 v[30:31], v[42:43], v[104:105], v[30:31] op_sel_hi:[1,0,1]
    s_waitcnt vmcnt(8) lgkmcnt(2)
    v_lshlrev_b32 v40, 16, v84
    v_and_b32 v41, 0xffff0000, v84
    v_pk_fma_f32 v[24:25], v[40:41], v[106:107], v[24:25] op_sel_hi:[1,0,1]
    v_lshlrev_b32 v42, 16, v85
    v_and_b32 v43, 0xffff0000, v85
    v_pk_fma_f32 v[26:27], v[42:43], v[106:107], v[26:27] op_sel_hi:[1,0,1]
    v_lshlrev_b32 v40, 16, v86
    v_and_b32 v41, 0xffff0000, v86
    v_pk_fma_f32 v[28:29], v[40:41], v[106:107], v[28:29] op_sel_hi:[1,0,1]
    v_lshlrev_b32 v42, 16, v87
    v_and_b32 v43, 0xffff0000, v87
    v_pk_fma_f32 v[30:31], v[42:43], v[106:107], v[30:31] op_sel_hi:[1,0,1]
    s_waitcnt vmcnt(7) lgkmcnt(1)
    v_lshlrev_b32 v40, 16, v88
    v_and_b32 v41, 0xffff0000, v88
    v_pk_fma_f32 v[24:25], v[40:41], v[108:109], v[24:25] op_sel_hi:[1,0,1]
    v_lshlrev_b32 v42, 16, v89
    v_and_b32 v43, 0xffff0000, v89
    v_pk_fma_f32 v[26:27], v[42:43], v[108:109], v[26:27] op_sel_hi:[1,0,1]
    v_lshlrev_b32 v40, 16, v90
    v_and_b32 v41, 0xffff0000, v90
    v_pk_fma_f32 v[28:29], v[40:41], v[108:109], v[28:29] op_sel_hi:[1,0,1]
    v_lshlrev_b32 v42, 16, v91
    v_and_b32 v43, 0xffff0000, v91
    v_pk_fma_f32 v[30:31], v[42:43], v[108:109], v[30:31] op_sel_hi:[1,0,1]
    s_waitcnt vmcnt(6) lgkmcnt(0)
    v_lshlrev_b32 v40, 16, v92
    v_and_b32 v41, 0xffff0000, v92
    v_pk_fma_f32 v[24:25], v[40:41], v[110:111], v[24:25] op_sel_hi:[1,0,1]
    v_lshlrev_b32 v42, 16, v93
    v_and_b32 v43, 0xffff0000, v93
    v_pk_fma_f32 v[26:27], v[42:43], v[110:111], v[26:27] op_sel_hi:[1,0,1]
    v_lshlrev_b32 v40, 16, v94
    v_and_b32 v41, 0xffff0000, v94
    v_pk_fma_f32 v[28:29], v[40:41], v[110:111], v[28:29] op_sel_hi:[1,0,1]
    v_lshlrev_b32 v42, 16, v95
    v_and_b32 v43, 0xffff0000, v95
    v_pk_fma_f32 v[30:31], v[42:43], v[110:111], v[30:31] op_sel_hi:[1,0,1]
    s_branch K3_CC
K3_CB:
    s_waitcnt vmcnt(8)
    v_mov_b32 v18, v16
    s_nop 1
    v_max_f32_dpp v18, v18, v18 row_shr:1 row_mask:0xf bank_mask:0xf
    s_nop 1
    v_max_f32_dpp v18, v18, v18 row_shr:2 row_mask:0xf bank_mask:0xf
    s_nop 1
    v_max_f32_dpp v18, v18, v18 row_shr:4 row_mask:0xf bank_mask:0xf
    s_nop 1
    v_max_f32_dpp v18, v18, v18 row_shr:8 row_mask:0xf bank_mask:0xf
    s_nop 1
    v_readlane_b32 s64, v18, 15
    v_readlane_b32 s65, v18, 31
    s_nop 1
    v_mov_b32 v18, s64
    v_max_f32 v18, s65, v18
    v_sub_f32 v19, v16, v18
    v_mul_f32 v19, 0x3fb8aa3b, v19
    v_exp_f32 v19, v19
    s_nop 0
    v_mul_f32 v20, v19, v17
    s_nop 1
    v_add_f32_dpp v20, v20, v20 row_shr:1 row_mask:0xf bank_mask:0xf bound_ctrl:0
    s_nop 1
    v_add_f32_dpp v20, v20, v20 row_shr:2 row_mask:0xf bank_mask:0xf bound_ctrl:0
    s_nop 1
    v_add_f32_dpp v20, v20, v20 row_shr:4 row_mask:0xf bank_mask:0xf bound_ctrl:0
    s_nop 1
    v_add_f32_dpp v20, v20, v20 row_shr:8 row_mask:0xf bank_mask:0xf bound_ctrl:0
    s_nop 1
    v_readlane_b32 s64, v20, 15
    v_readlane_b32 s65, v20, 31
    s_nop 1
    v_mov_b32 v20, s64
    v_add_f32 v20, s65, v20
    v_rcp_f32 v20, v20
    s_nop 0
    v_mul_f32 v19, v19, v20
    ds_bpermute_b32 v96, v13, v19 offset:0
    ds_bpermute_b32 v98, v13, v19 offset:16
    ds_bpermute_b32 v100, v13, v19 offset:32
    ds_bpermute_b32 v102, v13, v19 offset:48
    ds_bpermute_b32 v104, v13, v19 offset:64
    ds_bpermute_b32 v106, v13, v19 offset:80
    ds_bpermute_b32 v108, v13, v19 offset:96
    ds_bpermute_b32 v110, v13, v19 offset:112
    s_waitcnt vmcnt(7) lgkmcnt(7)
    v_lshlrev_b32 v40, 16, v64
    v_and_b32 v41, 0xffff0000, v64
    v_pk_mul_f32 v[24:25], v[40:41], v[96:97] op_sel_hi:[1,0]
    v_lshlrev_b32 v42, 16, v65
    v_and_b32 v43, 0xffff0000, v65
    v_pk_mul_f32 v[26:27], v[42:43], v[96:97] op_sel_hi:[1,0]
    v_lshlrev_b32 v40, 16, v66
    v_and_b32 v41, 0xffff0000, v66
    v_pk_mul_f32 v[28:29], v[40:41], v[96:97] op_sel_hi:[1,0]
    v_lshlrev_b32 v42, 16, v67
    v_and_b32 v43, 0xffff0000, v67
    v_pk_mul_f32 v[30:31], v[42:43], v[96:97] op_sel_hi:[1,0]
    s_waitcnt vmcnt(6) lgkmcnt(6)
    v_lshlrev_b32 v40, 16, v68
    v_and_b32 v41, 0xffff0000, v68
    v_pk_fma_f32 v[24:25], v[40:41], v[98:99], v[24:25] op_sel_hi:[1,0,1]
    v_lshlrev_b32 v42, 16, v69
    v_and_b32 v43, 0xffff0000, v69
    v_pk_fma_f32 v[26:27], v[42:43], v[98:99], v[26:27] op_sel_hi:[1,0,1]
    v_lshlrev_b32 v40, 16, v70
    v_and_b32 v41, 0xffff0000, v70
    v_pk_fma_f32 v[28:29], v[40:41], v[98:99], v[28:29] op_sel_hi:[1,0,1]
    v_lshlrev_b32 v42, 16, v71
    v_and_b32 v43, 0xffff0000, v71
    v_pk_fma_f32 v[30:31], v[42:43], v[98:99], v[30:31] op_sel_hi:[1,0,1]
    s_waitcnt vmcnt(5) lgkmcnt(5)
    v_lshlrev_b32 v40, 16, v72
    v_and_b32 v41, 0xffff0000, v72
    v_pk_fma_f32 v[24:25], v[40:41], v[100:101], v[24:25] op_sel_hi:[1,0,1]
    v_lshlrev_b32 v42, 16, v73
    v_and_b32 v43, 0xffff0000, v73
    v_pk_fma_f32 v[26:27], v[42:43], v[100:101], v[26:27] op_sel_hi:[1,0,1]
    v_lshlrev_b32 v40, 16, v74
    v_and_b32 v41, 0xffff0000, v74
    v_pk_fma_f32 v[28:29], v[40:41], v[100:101], v[28:29] op_sel_hi:[1,0,1]
    v_lshlrev_b32 v42, 16, v75
    v_and_b32 v43, 0xffff0000, v75
    v_pk_fma_f32 v[30:31], v[42:43], v[100:101], v[30:31] op_sel_hi:[1,0,1]
    s_waitcnt vmcnt(4) lgkmcnt(4)
    v_lshlrev_b32 v40, 16, v76
    v_and_b32 v41, 0xffff0000, v76
    v_pk_fma_f32 v[24:25], v[40:41], v[102:103], v[24:25] op_sel_hi:[1,0,1]
    v_lshlrev_b32 v42, 16, v77
    v_and_b32 v43, 0xffff0000, v77
    v_pk_fma_f32 v[26:27], v[42:43], v[102:103], v[26:27] op_sel_hi:[1,0,1]
    v_lshlrev_b32 v40, 16, v78
    v_and_b32 v41, 0xffff0000, v78
    v_pk_fma_f32 v[28:29], v[40:41], v[102:103], v[28:29] op_sel_hi:[1,0,1]
    v_lshlrev_b32 v42, 16, v79
    v_and_b32 v43, 0xffff0000, v79
    v_pk_fma_f32 v[30:31], v[42:43], v[102:103], v[30:31] op_sel_hi:[1,0,1]
    s_waitcnt vmcnt(3) lgkmcnt(3)
    v_lshlrev_b32 v40, 16, v80
    v_and_b32 v41, 0xffff0000, v80
    v_pk_fma_f32 v[24:25], v[40:41], v[104:105], v[24:25] op_sel_hi:[1,0,1]
    v_lshlrev_b32 v42, 16, v81
    v_and_b32 v43, 0xffff0000, v81
    v_pk_fma_f32 v[26:27], v[42:43], v[104:105], v[26:27] op_sel_hi:[1,0,1]
    v_lshlrev_b32 v40, 16, v82
    v_and_b32 v41, 0xffff0000, v82
    v_pk_fma_f32 v[28:29], v[40:41], v[104:105], v[28:29] op_sel_hi:[1,0,1]
    v_lshlrev_b32 v42, 16, v83
    v_and_b32 v43, 0xffff0000, v83
    v_pk_fma_f32 v[30:31], v[42:43], v[104:105], v[30:31] op_sel_hi:[1,0,1]
    s_waitcnt vmcnt(2) lgkmcnt(2)
    v_lshlrev_b32 v40, 16, v84
    v_and_b32 v41, 0xffff0000, v84
    v_pk_fma_f32 v[24:25], v[40:41], v[106:107], v[24:25] op_sel_hi:[1,0,1]
    v_lshlrev_b32 v42, 16, v85
    v_and_b32 v43, 0xffff0000, v85
    v_pk_fma_f32 v[26:27], v[42:43], v[106:107], v[26:27] op_sel_hi:[1,0,1]
    v_lshlrev_b32 v40, 16, v86
    v_and_b32 v41, 0xffff0000, v86
    v_pk_fma_f32 v[28:29], v[40:41], v[106:107], v[28:29] op_sel_hi:[1,0,1]
    v_lshlrev_b32 v42, 16, v87
    v_and_b32 v43, 0xffff0000, v87
    v_pk_fma_f32 v[30:31], v[42:43], v[106:107], v[30:31] op_sel_hi:[1,0,1]
    s_waitcnt vmcnt(1) lgkmcnt(1)
    v_lshlrev_b32 v40, 16, v88
    v_and_b32 v41, 0xffff0000, v88
    v_pk_fma_f32 v[24:25], v[40:41], v[108:109], v[24:25] op_sel_hi:[1,0,1]
    v_lshlrev_b32 v42, 16, v89
    v_and_b32 v43, 0xffff0000, v89
    v_pk_fma_f32 v[26:27], v[42:43], v[108:109], v[26:27] op_sel_hi:[1,0,1]
    v_lshlrev_b32 v40, 16, v90
    v_and_b32 v41, 0xffff0000, v90
    v_pk_fma_f32 v[28:29], v[40:41], v[108:109], v[28:29] op_sel_hi:[1,0,1]
    v_lshlrev_b32 v42, 16, v91
    v_and_b32 v43, 0xffff0000, v91
    v_pk_fma_f32 v[30:31], v[42:43], v[108:109], v[30:31] op_sel_hi:[1,0,1]
    s_waitcnt vmcnt(0) lgkmcnt(0)
    v_lshlrev_b32 v40, 16, v92
    v_and_b32 v41, 0xffff0000, v92
    v_pk_fma_f32 v[24:25], v[40:41], v[110:111], v[24:25] op_sel_hi:[1,0,1]
    v_lshlrev_b32 v42, 16, v93
    v_and_b32 v43, 0xffff0000, v93
    v_pk_fma_f32 v[26:27], v[42:43], v[110:111], v[26:27] op_sel_hi:[1,0,1]
    v_lshlrev_b32 v40, 16, v94
    v_and_b32 v41, 0xffff0000, v94
    v_pk_fma_f32 v[28:29], v[40:41], v[110:111], v[28:29] op_sel_hi:[1,0,1]
    v_lshlrev_b32 v42, 16, v95
    v_and_b32 v43, 0xffff0000, v95
    v_pk_fma_f32 v[30:31], v[42:43], v[110:111], v[30:31] op_sel_hi:[1,0,1]
K3_CC:
    v_mov_b32 v32, v24
    v_mov_b32 v33, v25
    v_mov_b32 v34, v26
    v_mov_b32 v35, v27
    v_mov_b32 v36, v28
    v_mov_b32 v37, v29
    v_mov_b32 v38, v30
    v_mov_b32 v39, v31
    s_nop 0
    v_permlane32_swap_b32 v24, v32
    v_permlane32_swap_b32 v25, v33
    v_permlane32_swap_b32 v26, v34
    v_permlane32_swap_b32 v27, v35
    v_permlane32_swap_b32 v28, v36
    v_permlane32_swap_b32 v29, v37
    v_permlane32_swap_b32 v30, v38
    v_permlane32_swap_b32 v31, v39
    s_nop 0
    v_add_f32 v24, v24, v32
    v_add_f32 v25, v25, v33
    v_add_f32 v26, v26, v34
    v_add_f32 v27, v27, v35
    v_add_f32 v28, v28, v36
    v_add_f32 v29, v29, v37
    v_add_f32 v30, v30, v38
    v_add_f32 v31, v31, v39
    v_mov_b32 v32, v24
    v_mov_b32 v33, v25
    v_mov_b32 v34, v26
    v_mov_b32 v35, v27
    v_mov_b32 v36, v28
    v_mov_b32 v37, v29
    v_mov_b32 v38, v30
    v_mov_b32 v39, v31
    s_nop 0
    v_permlane16_swap_b32 v24, v32
    v_permlane16_swap_b32 v25, v33
    v_permlane16_swap_b32 v26, v34
    v_permlane16_swap_b32 v27, v35
    v_permlane16_swap_b32 v28, v36
    v_permlane16_swap_b32 v29, v37
    v_permlane16_swap_b32 v30, v38
    v_permlane16_swap_b32 v31, v39
    s_nop 0
    v_add_f32 v24, v24, v32
    v_add_f32 v25, v25, v33
    v_add_f32 v26, v26, v34
    v_add_f32 v27, v27, v35
    v_add_f32 v28, v28, v36
    v_add_f32 v29, v29, v37
    v_add_f32 v30, v30, v38
    v_add_f32 v31, v31, v39
    v_cvt_pk_bf16_f32 v32, v24, v25
    v_cvt_pk_bf16_f32 v33, v26, v27
    v_cvt_pk_bf16_f32 v34, v28, v29
    v_cvt_pk_bf16_f32 v35, v30, v31
    s_mul_i32 s64, s55, 1088
    s_lshl_b32 s65, s62, 8
    s_add_u32 s64, s64, s65
    s_add_u32 s64, s64, 32768
    v_lshl_add_u32 v4, v3, 4, s64
    ds_write_b128 v4, v[32:35]
    v_and_b32 v6, 3, v3
    v_mul_u32_u24 v6, 1088, v6
    v_lshl_add_u32 v6, v2, 4, v6
    s_lshl_b32 s64, s52, 8
    s_add_u32 s64, s64, 32768
    v_add_u32 v6, s64, v6
    v_bfe_u32 v7, v1, 2, 2
    v_lshl_add_u32 v4, v2, 3, v7
    v_lshlrev_b32 v4, 5, v4
    v_and_b32 v8, 3, v1
    v_lshl_add_u32 v4, v8, 3, v4
    s_lshl_b32 s64, s52, 12
    v_add_u32 v4, s64, v4
    s_waitcnt lgkmcnt(0)
    s_barrier
    s_cmp_ge_u32 s52, 4
    s_cbranch_scc1 K3_DOWN
    s_setprio 3
    ds_read_b128 v[64:67], v6 offset:0
    ds_read_b64_tr_b16 v[80:81], v4 offset:0
    ds_read_b64_tr_b16 v[82:83], v4 offset:128
    ds_read_b128 v[68:71], v6 offset:64
    ds_read_b64_tr_b16 v[84:85], v4 offset:1024
    ds_read_b64_tr_b16 v[86:87], v4 offset:1152
    ds_read_b128 v[72:75], v6 offset:128
    ds_read_b64_tr_b16 v[88:89], v4 offset:2048
    ds_read_b64_tr_b16 v[90:91], v4 offset:2176
    ds_read_b128 v[76:79], v6 offset:192
    ds_read_b64_tr_b16 v[92:93], v4 offset:3072
    ds_read_b64_tr_b16 v[94:95], v4 offset:3200
    v_lshl_add_u32 v9, v2, 2, v7
    v_and_b32 v5, 7, v9
    v_lshlrev_b32 v9, 10, v9
    v_lshl_add_u32 v9, v8, 3, v9
    s_lshl_b32 s64, s52, 8
    s_add_u32 s64, s64, 16384
    v_add_u32 v9, s64, v9
    s_waitcnt lgkmcnt(9)
    v_mfma_f32_16x16x32_bf16 v[32:35], v[80:83], v[64:67], 0
    s_waitcnt lgkmcnt(6)
    v_mfma_f32_16x16x32_bf16 v[32:35], v[84:87], v[68:71], v[32:35]
    s_waitcnt lgkmcnt(3)
    v_mfma_f32_16x16x32_bf16 v[32:35], v[88:91], v[72:75], v[32:35]
    s_waitcnt lgkmcnt(0)
    v_mfma_f32_16x16x32_bf16 v[32:35], v[92:95], v[76:79], v[32:35]
    v_lshlrev_b32 v4, 6, v3
    v_lshl_add_u32 v4, v2, 4, v4
    s_lshl_b32 s64, s52, 8
    s_add_u32 s64, s64, 37120
    v_add_u32 v4, s64, v4
    v_and_b32 v6, 3, v3
    v_lshlrev_b32 v6, 6, v6
    v_lshl_add_u32 v6, v2, 4, v6
    v_add_u32 v6, 37120, v6
    s_mov_b64 exec, s[72:73]
    ds_write_b128 v4, v[32:35]
    s_mov_b64 exec, -1
    s_waitcnt vmcnt(0) lgkmcnt(0)
    s_barrier
    v_xor_b32 v10, 0, v5
    v_lshl_add_u32 v10, v10, 5, v9
    ds_read_b64_tr_b16 v[96:97], v10
    v_xor_b32 v10, 1, v5
    v_lshl_add_u32 v10, v10, 5, v9
    ds_read_b64_tr_b16 v[98:99], v10
    v_xor_b32 v10, 2, v5
    v_lshl_add_u32 v10, v10, 5, v9
    ds_read_b64_tr_b16 v[100:101], v10
    v_xor_b32 v10, 3, v5
    v_lshl_add_u32 v10, v10, 5, v9
    ds_read_b64_tr_b16 v[102:103], v10
    v_xor_b32 v10, 4, v5
    v_lshl_add_u32 v10, v10, 5, v9
    ds_read_b64_tr_b16 v[104:105], v10
    v_xor_b32 v10, 5, v5
    v_lshl_add_u32 v10, v10, 5, v9
    ds_read_b64_tr_b16 v[106:107], v10
    v_xor_b32 v10, 6, v5
    v_lshl_add_u32 v10, v10, 5, v9
    ds_read_b64_tr_b16 v[108:109], v10
    v_xor_b32 v10, 7, v5
    v_lshl_add_u32 v10, v10, 5, v9
    ds_read_b64_tr_b16 v[110:111], v10
    ds_read_b128 v[64:67], v6 offset:0
    ds_read_b128 v[68:71], v6 offset:256
    ds_read_b128 v[72:75], v6 offset:512
    ds_read_b128 v[76:79], v6 offset:768
    s_lshl_b32 s64, s2, 13
    s_lshl_b32 s65, s52, 11
    s_add_u32 s64, s64, s65
    s_add_u32 s64, s64, 4390912
    s_waitcnt lgkmcnt(0)
    v_add_f32 v64, v64, v68
    v_add_f32 v72, v72, v76
    v_add_f32 v64, v64, v72
    v_add_f32 v65, v65, v69
    v_add_f32 v73, v73, v77
    v_add_f32 v65, v65, v73
    v_add_f32 v66, v66, v70
    v_add_f32 v74, v74, v78
    v_add_f32 v66, v66, v74
    v_add_f32 v67, v67, v71
    v_add_f32 v75, v75, v79
    v_add_f32 v67, v67, v75
    v_cvt_pk_bf16_f32 v42, v64, v65
    v_cvt_pk_bf16_f32 v43, v66, v67
    s_nop 1
    v_mfma_f32_16x16x16_bf16 v[64:67], v[96:97], v[42:43], 0
    v_mfma_f32_16x16x16_bf16 v[68:71], v[98:99], v[42:43], 0
    v_mfma_f32_16x16x16_bf16 v[72:75], v[100:101], v[42:43], 0
    v_mfma_f32_16x16x16_bf16 v[76:79], v[102:103], v[42:43], 0
    v_mfma_f32_16x16x16_bf16 v[80:83], v[104:105], v[42:43], 0
    v_mfma_f32_16x16x16_bf16 v[84:87], v[106:107], v[42:43], 0
    v_mfma_f32_16x16x16_bf16 v[88:91], v[108:109], v[42:43], 0
    v_mfma_f32_16x16x16_bf16 v[92:95], v[110:111], v[42:43], 0
    s_nop 7
    v_mov_b32_dpp v64, v68 row_shr:4 row_mask:0xf bank_mask:0x2
    v_mov_b32_dpp v65, v69 row_shr:4 row_mask:0xf bank_mask:0x2
    v_mov_b32_dpp v66, v70 row_shr:4 row_mask:0xf bank_mask:0x2
    v_mov_b32_dpp v67, v71 row_shr:4 row_mask:0xf bank_mask:0x2
    v_mov_b32_dpp v64, v72 row_shr:8 row_mask:0xf bank_mask:0x4
    v_mov_b32_dpp v65, v73 row_shr:8 row_mask:0xf bank_mask:0x4
    v_mov_b32_dpp v66, v74 row_shr:8 row_mask:0xf bank_mask:0x4
    v_mov_b32_dpp v67, v75 row_shr:8 row_mask:0xf bank_mask:0x4
    v_mov_b32_dpp v64, v76 row_shr:12 row_mask:0xf bank_mask:0x8
    v_mov_b32_dpp v65, v77 row_shr:12 row_mask:0xf bank_mask:0x8
    v_mov_b32_dpp v66, v78 row_shr:12 row_mask:0xf bank_mask:0x8
    v_mov_b32_dpp v67, v79 row_shr:12 row_mask:0xf bank_mask:0x8
    v_mov_b32_dpp v80, v84 row_shr:4 row_mask:0xf bank_mask:0x2
    v_mov_b32_dpp v81, v85 row_shr:4 row_mask:0xf bank_mask:0x2
    v_mov_b32_dpp v82, v86 row_shr:4 row_mask:0xf bank_mask:0x2
    v_mov_b32_dpp v83, v87 row_shr:4 row_mask:0xf bank_mask:0x2
    v_mov_b32_dpp v80, v88 row_shr:8 row_mask:0xf bank_mask:0x4
    v_mov_b32_dpp v81, v89 row_shr:8 row_mask:0xf bank_mask:0x4
    v_mov_b32_dpp v82, v90 row_shr:8 row_mask:0xf bank_mask:0x4
    v_mov_b32_dpp v83, v91 row_shr:8 row_mask:0xf bank_mask:0x4
    v_mov_b32_dpp v80, v92 row_shr:12 row_mask:0xf bank_mask:0x8
    v_mov_b32_dpp v81, v93 row_shr:12 row_mask:0xf bank_mask:0x8
    v_mov_b32_dpp v82, v94 row_shr:12 row_mask:0xf bank_mask:0x8
    v_mov_b32_dpp v83, v95 row_shr:12 row_mask:0xf bank_mask:0x8
    buffer_store_dwordx4 v[64:67], v11, s[48:51], s64 offen sc1
    buffer_store_dwordx4 v[80:83], v11, s[48:51], s64 offen offset:1024 sc1
    s_branch K3_FIN
K3_DOWN:
    s_cmp_lt_u32 s52, 12
    s_cbranch_scc1 K3_DOWN2
    s_waitcnt vmcnt(0)
    s_barrier
    s_branch K3_FIN
K3_DOWN2:
    v_lshl_add_u32 v9, v2, 2, v7
    v_min_u32 v9, 6, v9
    v_lshlrev_b32 v5, 10, v9
    v_lshl_add_u32 v5, v8, 3, v5
    v_add_u32 v5, 38144, v5
    s_sub_u32 s65, s52, 4
    s_lshl_b32 s65, s65, 2
    s_barrier
    s_add_u32 s66, s65, 0
    v_xor_b32 v6, s66, v9
    v_lshl_add_u32 v6, v6, 5, v5
    ds_read_b64_tr_b16 v[96:97], v6
    s_add_u32 s66, s65, 1
    v_xor_b32 v6, s66, v9
    v_lshl_add_u32 v6, v6, 5, v5
    ds_read_b64_tr_b16 v[98:99], v6
    s_add_u32 s66, s65, 2
    v_xor_b32 v6, s66, v9
    v_lshl_add_u32 v6, v6, 5, v5
    ds_read_b64_tr_b16 v[100:101], v6
    s_add_u32 s66, s65, 3
    v_xor_b32 v6, s66, v9
    v_lshl_add_u32 v6, v6, 5, v5
    ds_read_b64_tr_b16 v[102:103], v6
    v_mov_b32 v42, v22
    v_mov_b32 v43, v23
    s_waitcnt lgkmcnt(0)
    s_add_u32 s66, s2, 256
    s_lshl_b32 s66, s66, 13
    v_mfma_f32_16x16x16_bf16 v[72:75], v[96:97], v[42:43], 0
    v_mfma_f32_16x16x16_bf16 v[76:79], v[98:99], v[42:43], 0
    v_mfma_f32_16x16x16_bf16 v[80:83], v[100:101], v[42:43], 0
    v_mfma_f32_16x16x16_bf16 v[84:87], v[102:103], v[42:43], 0
    s_lshl_b32 s65, s65, 8
    s_add_u32 s66, s66, s65
    s_add_u32 s66, s66, 4390912
    s_nop 7
    v_mov_b32_dpp v72, v76 row_shr:4 row_mask:0xf bank_mask:0x2
    v_mov_b32_dpp v73, v77 row_shr:4 row_mask:0xf bank_mask:0x2
    v_mov_b32_dpp v74, v78 row_shr:4 row_mask:0xf bank_mask:0x2
    v_mov_b32_dpp v75, v79 row_shr:4 row_mask:0xf bank_mask:0x2
    v_mov_b32_dpp v72, v80 row_shr:8 row_mask:0xf bank_mask:0x4
    v_mov_b32_dpp v73, v81 row_shr:8 row_mask:0xf bank_mask:0x4
    v_mov_b32_dpp v74, v82 row_shr:8 row_mask:0xf bank_mask:0x4
    v_mov_b32_dpp v75, v83 row_shr:8 row_mask:0xf bank_mask:0x4
    v_mov_b32_dpp v72, v84 row_shr:12 row_mask:0xf bank_mask:0x8
    v_mov_b32_dpp v73, v85 row_shr:12 row_mask:0xf bank_mask:0x8
    v_mov_b32_dpp v74, v86 row_shr:12 row_mask:0xf bank_mask:0x8
    v_mov_b32_dpp v75, v87 row_shr:12 row_mask:0xf bank_mask:0x8
    buffer_store_dwordx4 v[72:75], v11, s[48:51], s66 offen sc1
K3_FIN:
K3_END:
    s_endpgm
.globl k4_kernel
.p2align 8
.type k4_kernel,@function
k4_kernel:
    s_cmp_ge_u32 s2, 64
    s_cbranch_scc1 K4_END
    s_load_dwordx2 s[4:5], s[0:1], 0
    s_load_dwordx2 s[8:9], s[0:1], 88
    s_load_dwordx2 s[20:21], s[0:1], 104
    v_and_b32 v1, 63, v0
    v_lshrrev_b32 v4, 6, v0
    v_lshrrev_b32 v2, 3, v0
    v_readfirstlane_b32 s52, v4
    s_lshr_b32 s53, s2, 3
    s_and_b32 s54, s2, 7
    v_and_b32 v3, 7, v0
    v_lshlrev_b32 v4, 13, v2
    v_lshl_add_u32 v4, v3, 4, v4
    s_lshl_b32 s60, s2, 7
    s_add_u32 s60, s60, 4390912
    v_bfe_u32 v8, v1, 2, 2
    v_bfe_u32 v5, v1, 4, 1
    v_lshlrev_b32 v5, 4, v5
    v_and_b32 v6, 3, v1
    v_add_u32 v5, v5, v6
    s_lshl_b32 s61, s53, 6
    s_and_b32 s62, s54, 1
    s_lshl_b32 s62, s62, 5
    s_add_u32 s61, s61, s62
    s_lshr_b32 s62, s54, 1
    s_lshl_b32 s62, s62, 2
    s_add_u32 s61, s61, s62
    v_add_u32 v5, s61, v5
    v_lshlrev_b32 v5, 1, v5
    v_lshl_add_u32 v5, v8, 10, v5
    v_lshlrev_b32 v6, 2, v8
    s_waitcnt lgkmcnt(0)
    s_mov_b32 s24, s4
    s_and_b32 s25, s5, 0xffff
    s_mov_b32 s26, 0x1000
    s_mov_b32 s27, 0x00020000
    s_mov_b32 s28, s8
    s_and_b32 s29, s9, 0xffff
    s_mov_b32 s30, 0x1000
    s_mov_b32 s31, 0x00020000
    s_mov_b32 s48, s20
    s_and_b32 s49, s21, 0xffff
    s_mov_b32 s50, 0x830000
    s_mov_b32 s51, 0x00020000
    s_add_u32 s61, s60, 0
    buffer_load_dwordx4 v[16:19], v4, s[48:51], s61 offen
    s_add_u32 s61, s60, 524288
    buffer_load_dwordx4 v[20:23], v4, s[48:51], s61 offen
    s_add_u32 s61, s60, 1048576
    buffer_load_dwordx4 v[24:27], v4, s[48:51], s61 offen
    s_add_u32 s61, s60, 1572864
    buffer_load_dwordx4 v[28:31], v4, s[48:51], s61 offen
    s_add_u32 s61, s60, 2097152
    buffer_load_dwordx4 v[32:35], v4, s[48:51], s61 offen
    s_add_u32 s61, s60, 2621440
    buffer_load_dwordx4 v[36:39], v4, s[48:51], s61 offen
    s_add_u32 s61, s60, 3145728
    buffer_load_dwordx4 v[40:43], v4, s[48:51], s61 offen
    s_add_u32 s61, s60, 3670016
    buffer_load_dwordx4 v[44:47], v4, s[48:51], s61 offen
    buffer_load_ushort v50, v5, s[24:27], 0 offen
    s_mov_b32 s62, 147456
    buffer_load_ushort v51, v5, s[48:51], s62 offen
    s_mov_b32 s62, 151552
    buffer_load_dword v52, v6, s[48:51], s62 offen
    s_waitcnt vmcnt(3)
    v_add_f32 v16, v16, v20
    v_add_f32 v24, v24, v28
    v_add_f32 v16, v16, v24
    v_add_f32 v32, v32, v36
    v_add_f32 v40, v40, v44
    v_add_f32 v20, v32, v40
    v_add_f32 v17, v17, v21
    v_add_f32 v25, v25, v29
    v_add_f32 v17, v17, v25
    v_add_f32 v33, v33, v37
    v_add_f32 v41, v41, v45
    v_add_f32 v21, v33, v41
    v_add_f32 v18, v18, v22
    v_add_f32 v26, v26, v30
    v_add_f32 v18, v18, v26
    v_add_f32 v34, v34, v38
    v_add_f32 v42, v42, v46
    v_add_f32 v22, v34, v42
    v_add_f32 v19, v19, v23
    v_add_f32 v27, v27, v31
    v_add_f32 v19, v19, v27
    v_add_f32 v35, v35, v39
    v_add_f32 v43, v43, v47
    v_add_f32 v23, v35, v43
    s_nop 1
    v_add_f32_dpp v16, v16, v16 row_shr:8 row_mask:0xf bank_mask:0xf bound_ctrl:0
    v_add_f32_dpp v17, v17, v17 row_shr:8 row_mask:0xf bank_mask:0xf bound_ctrl:0
    v_add_f32_dpp v18, v18, v18 row_shr:8 row_mask:0xf bank_mask:0xf bound_ctrl:0
    v_add_f32_dpp v19, v19, v19 row_shr:8 row_mask:0xf bank_mask:0xf bound_ctrl:0
    v_add_f32_dpp v20, v20, v20 row_shr:8 row_mask:0xf bank_mask:0xf bound_ctrl:0
    v_add_f32_dpp v21, v21, v21 row_shr:8 row_mask:0xf bank_mask:0xf bound_ctrl:0
    v_add_f32_dpp v22, v22, v22 row_shr:8 row_mask:0xf bank_mask:0xf bound_ctrl:0
    v_add_f32_dpp v23, v23, v23 row_shr:8 row_mask:0xf bank_mask:0xf bound_ctrl:0
    v_mov_b32 v24, v16
    v_mov_b32 v25, v17
    v_mov_b32 v26, v18
    v_mov_b32 v27, v19
    v_mov_b32 v28, v20
    v_mov_b32 v29, v21
    v_mov_b32 v30, v22
    v_mov_b32 v31, v23
    s_nop 1
    v_permlane32_swap_b32 v16, v24
    v_permlane32_swap_b32 v17, v25
    v_permlane32_swap_b32 v18, v26
    v_permlane32_swap_b32 v19, v27
    v_permlane32_swap_b32 v20, v28
    v_permlane32_swap_b32 v21, v29
    v_permlane32_swap_b32 v22, v30
    v_permlane32_swap_b32 v23, v31
    s_nop 1
    v_add_f32 v16, v16, v24
    v_add_f32 v17, v17, v25
    v_add_f32 v18, v18, v26
    v_add_f32 v19, v19, v27
    v_add_f32 v20, v20, v28
    v_add_f32 v21, v21, v29
    v_add_f32 v22, v22, v30
    v_add_f32 v23, v23, v31
    v_mov_b32 v24, v16
    v_mov_b32 v25, v17
    v_mov_b32 v26, v18
    v_mov_b32 v27, v19
    v_mov_b32 v28, v20
    v_mov_b32 v29, v21
    v_mov_b32 v30, v22
    v_mov_b32 v31, v23
    s_nop 1
    v_permlane16_swap_b32 v16, v24
    v_permlane16_swap_b32 v17, v25
    v_permlane16_swap_b32 v18, v26
    v_permlane16_swap_b32 v19, v27
    v_permlane16_swap_b32 v20, v28
    v_permlane16_swap_b32 v21, v29
    v_permlane16_swap_b32 v22, v30
    v_permlane16_swap_b32 v23, v31
    s_nop 1
    v_add_f32 v16, v16, v24
    v_add_f32 v17, v17, v25
    v_add_f32 v18, v18, v26
    v_add_f32 v19, v19, v27
    v_add_f32 v20, v20, v28
    v_add_f32 v21, v21, v29
    v_add_f32 v22, v22, v30
    v_add_f32 v23, v23, v31
    s_lshl_b32 s62, s52, 8
    v_lshl_add_u32 v6, v3, 4, s62
    v_and_b32 v7, 56, v1
    v_cmp_eq_u32 vcc, 8, v7
    s_and_saveexec_b64 s[72:73], vcc
    ds_write_b128 v6, v[16:19]
    ds_write_b128 v6, v[20:23] offset:128
    s_mov_b64 exec, s[72:73]
    s_waitcnt lgkmcnt(0)
    s_barrier
    s_cmp_lg_u32 s52, 0
    s_cbranch_scc1 K4_FIN
    v_and_b32 v6, 31, v1
    v_lshlrev_b32 v6, 2, v6
    ds_read_b32 v16, v6 offset:0
    ds_read_b32 v24, v6 offset:128
    ds_read_b32 v17, v6 offset:256
    ds_read_b32 v25, v6 offset:384
    ds_read_b32 v18, v6 offset:512
    ds_read_b32 v26, v6 offset:640
    ds_read_b32 v19, v6 offset:768
    ds_read_b32 v27, v6 offset:896
    ds_read_b32 v20, v6 offset:1024
    ds_read_b32 v28, v6 offset:1152
    ds_read_b32 v21, v6 offset:1280
    ds_read_b32 v29, v6 offset:1408
    ds_read_b32 v22, v6 offset:1536
    ds_read_b32 v30, v6 offset:1664
    ds_read_b32 v23, v6 offset:1792
    ds_read_b32 v31, v6 offset:1920
    s_waitcnt vmcnt(0) lgkmcnt(0)
    v_add_f32 v16, v16, v17
    v_add_f32 v24, v24, v25
    v_add_f32 v16, v16, v18
    v_add_f32 v24, v24, v26
    v_add_f32 v16, v16, v19
    v_add_f32 v24, v24, v27
    v_add_f32 v16, v16, v20
    v_add_f32 v24, v24, v28
    v_add_f32 v16, v16, v21
    v_add_f32 v24, v24, v29
    v_add_f32 v16, v16, v22
    v_add_f32 v24, v24, v30
    v_add_f32 v16, v16, v23
    v_add_f32 v24, v24, v31
    v_cvt_pk_bf16_f32 v16, v16, v16
    v_and_b32 v16, 0xffff0000, v16
    v_cvt_pk_bf16_f32 v20, v24, v24
    v_and_b32 v20, 0xffff0000, v20
    v_mul_f32 v20, v20, v52
    v_cvt_pk_bf16_f32 v20, v20, v20
    v_and_b32 v20, 0xffff0000, v20
    v_lshlrev_b32 v51, 16, v51
    v_lshlrev_b32 v50, 16, v50
    v_add_f32 v20, v51, v20
    v_cvt_pk_bf16_f32 v20, v20, v20
    v_and_b32 v20, 0xffff0000, v20
    v_mul_f32 v21, 0xbfb8aa3b, v20
    v_exp_f32 v21, v21
    s_nop 0
    v_add_f32 v21, 1.0, v21
    v_rcp_f32 v21, v21
    s_nop 0
    v_mul_f32 v20, v20, v21
    v_cvt_pk_bf16_f32 v20, v20, v20
    v_and_b32 v20, 0xffff0000, v20
    v_mul_f32 v16, v16, v20
    v_cvt_pk_bf16_f32 v16, v16, v16
    v_and_b32 v16, 0xffff0000, v16
    v_add_f32 v16, v50, v16
    v_cvt_pk_bf16_f32 v16, v16, v16
    v_cmp_gt_u32 vcc, 32, v1
    s_and_saveexec_b64 s[72:73], vcc
    buffer_store_short v16, v5, s[28:31], 0 offen sc1
K4_FIN:
K4_END:
    s_endpgm
.section .rodata,"a"
.p2align 6
.amdhsa_kernel k1_kernel
  .amdhsa_next_free_vgpr 128
  .amdhsa_next_free_sgpr 96
  .amdhsa_accum_offset 128
  .amdhsa_group_segment_fixed_size 0
  .amdhsa_kernarg_size 112
  .amdhsa_user_sgpr_count 2
  .amdhsa_user_sgpr_kernarg_segment_ptr 1
  .amdhsa_system_sgpr_workgroup_id_x 1
.end_amdhsa_kernel
.p2align 6
.amdhsa_kernel k2_kernel
  .amdhsa_next_free_vgpr 128
  .amdhsa_next_free_sgpr 96
  .amdhsa_accum_offset 128
  .amdhsa_group_segment_fixed_size 0
  .amdhsa_kernarg_size 112
  .amdhsa_user_sgpr_count 2
  .amdhsa_user_sgpr_kernarg_segment_ptr 1
  .amdhsa_system_sgpr_workgroup_id_x 1
.end_amdhsa_kernel
.p2align 6
.amdhsa_kernel k3_kernel
  .amdhsa_next_free_vgpr 128
  .amdhsa_next_free_sgpr 96
  .amdhsa_accum_offset 128
  .amdhsa_group_segment_fixed_size 0
  .amdhsa_kernarg_size 112
  .amdhsa_user_sgpr_count 2
  .amdhsa_user_sgpr_kernarg_segment_ptr 1
  .amdhsa_system_sgpr_workgroup_id_x 1
.end_amdhsa_kernel
.p2align 6
.amdhsa_kernel k4_kernel
  .amdhsa_next_free_vgpr 64
  .amdhsa_next_free_sgpr 96
  .amdhsa_accum_offset 64
  .amdhsa_group_segment_fixed_size 0
  .amdhsa_kernarg_size 112
  .amdhsa_user_sgpr_count 2
  .amdhsa_user_sgpr_kernarg_segment_ptr 1
  .amdhsa_system_sgpr_workgroup_id_x 1
.end_amdhsa_kernel
```
